```python
import torch

def _softmax(x, axis=-1):
    return torch.softmax(x, dim=axis)
def _gelu(x):
    return torch.nn.functional.gelu(x, approximate="tanh")
def _silu(x):
    return torch.nn.functional.silu(x)
def _sigmoid(x):
    return torch.sigmoid(x)
def _layernorm(x, axis=-1, eps=1e-5):
    m = x.mean(dim=axis, keepdim=True)
    v = x.var(dim=axis, keepdim=True, unbiased=False)
    return (x - m) / torch.sqrt(v + eps)
def _scatter_add(tgt, idx, src, axis=0):
    return tgt.clone().index_add_(axis, idx, src)
def _segment_sum(src, seg, n):
    out = torch.zeros((n,) + src.shape[1:], dtype=src.dtype)
    return out.index_add_(0, seg, src)
def _pad(x, pw):
    flat = tuple(v for pair in reversed(pw) for v in pair)
    return torch.nn.functional.pad(x, flat)

kernel_name = 'standalone__kv_cache_quant_int4_int2_kv_with_per_channel_or_per_token_scales__sampling'

def setup_inputs():

    _w = (lambda a: (lambda t: t.to(torch.bfloat16) if t.is_floating_point() else t)(torch.as_tensor(a)))
    B = 8
    Sq = 16
    Skv = 8192
    Hq = 32
    Hkv = 8
    Dh = 128
    bits = 4
    G = 128
    if G <= 0 or G >= Skv:
        G = max(1, Skv // 2)
    Skv = (Skv // G) * G
    ngk = Skv // G
    qmax = (1 << bits) - 1
    return {
        "q": _w((lambda *s: torch.randn(*s, dtype=torch.bfloat16) * 1.6)(B, Hq, Sq, Dh)),
        "qk": _w(torch.randint(0, qmax + 1, (B, Hkv, Skv, Dh)).to(torch.int32)),
        "qv": _w(torch.randint(0, qmax + 1, (B, Hkv, Skv, Dh)).to(torch.int32)),
        "k_scales": _w(torch.abs((lambda *s: torch.randn(*s, dtype=torch.bfloat16) * 1.6)(B, Hkv, ngk, Dh)) * 0.05 + 0.02),
        "k_zeros": _w((lambda *s: torch.randn(*s, dtype=torch.bfloat16) * 1.6)(B, Hkv, ngk, Dh) + float(qmax) / 2.0),
        "v_scales": _w(torch.abs((lambda *s: torch.randn(*s, dtype=torch.bfloat16) * 0.05)(B, Hkv, Skv, 1)) * 0.05 + 0.02),
        "v_zeros": _w((lambda *s: torch.randn(*s, dtype=torch.bfloat16) * 0.05)(B, Hkv, Skv, 1) + float(qmax) / 2.0),
    }

def reference(q, qk, qv, k_scales, k_zeros, v_scales, v_zeros):
    B, Hq, Sq, Dh = q.shape
    Hkv, Skv = qk.shape[1], qk.shape[2]
    ngk = k_scales.shape[2]
    G = Skv // ngk
    ks = (lambda x, n, axis: torch.repeat_interleave(x, n, dim=axis))(k_scales, G, axis=2)
    kz = (lambda x, n, axis: torch.repeat_interleave(x, n, dim=axis))(k_zeros, G, axis=2)
    k = ((lambda x, dt: x.to(dt))(qk, q.dtype) - kz) * ks
    v = ((lambda x, dt: x.to(dt))(qv, q.dtype) - v_zeros) * v_scales
    rep = Hq // Hkv
    if rep > 1:
        k = (lambda x, n, axis: torch.repeat_interleave(x, n, dim=axis))(k, rep, axis=1)
        v = (lambda x, n, axis: torch.repeat_interleave(x, n, dim=axis))(v, rep, axis=1)
    scale = float(Dh) ** -0.5
    logits = torch.einsum("bhqd,bhkd->bhqk", q, k) * scale
    p = _softmax(logits, axis=-1)
    o = torch.einsum("bhqk,bhkd->bhqd", p, v)
    return o
```

```asm
; @launch grid=(256,1,1) block=(256,1,1) lds=91904
.amdgcn_target "amdgcn-amd-amdhsa--gfx950"
.text
.globl standalone__kv_cache_quant_int4_int2_kv_with_per_channel_or_per_token_scales__sampling_kernel
.p2align 8
.type standalone__kv_cache_quant_int4_int2_kv_with_per_channel_or_per_token_scales__sampling_kernel,@function
standalone__kv_cache_quant_int4_int2_kv_with_per_channel_or_per_token_scales__sampling_kernel:
    s_cmp_ge_u32 s2, 256
    s_cbranch_scc1 L_end
    s_load_dwordx16 s[68:83], s[0:1], 0
    s_load_dwordx4 s[4:7], s[0:1], 64
    s_getpc_b64 s[92:93]
    s_and_b32 s92, s92, 0xffffff00
    s_mov_b32 s94, L_codeend-L_pf
    s_mov_b32 s95, 0x20000
L_pf:
    v_lshlrev_b32 v34, 7, v0
    s_lshr_b32 s46, s2, 3
    s_and_b32 s46, s46, 7
    s_cselect_b32 s94, 0, s94
    buffer_load_dword v34, v34, s[92:95], 0 offen
    v_lshrrev_b32 v1, 6, v0
    v_and_b32 v0, 63, v0
    v_readfirstlane_b32 s3, v1
    s_bitcmp1_b32 s2, 0
    s_cselect_b32 s46, 0x1000000, 0
    s_bitcmp1_b32 s2, 1
    s_cselect_b32 s45, 0x800000, 0
    s_xor_b32 s46, s46, s45
    s_bitcmp1_b32 s2, 2
    s_cselect_b32 s45, 0x4000000, 0
    s_xor_b32 s46, s46, s45
    s_bitcmp1_b32 s2, 3
    s_cselect_b32 s45, 0x2000000, 0
    s_xor_b32 s46, s46, s45
    s_bitcmp1_b32 s2, 4
    s_cselect_b32 s45, 0x100000, 0
    s_xor_b32 s46, s46, s45
    s_bitcmp1_b32 s2, 5
    s_cselect_b32 s45, 0x240000, 0
    s_xor_b32 s46, s46, s45
    s_bitcmp1_b32 s2, 6
    s_cselect_b32 s45, 0x4b0000, 0
    s_xor_b32 s46, s46, s45
    s_bitcmp1_b32 s2, 7
    s_cselect_b32 s45, 0x8044000, 0
    s_xor_b32 s46, s46, s45
    s_mov_b32 s59, s2
    s_lshr_b32 s40, s46, 22
    s_bfe_u32 s41, s46, 0x20014
    s_and_b32 s2, s46, 0x3fffff
    v_lshlrev_b32 v11, 4, v0
    s_and_b32 s45, s3, 1
    s_lshr_b32 s46, s3, 1
    s_lshl2_add_u32 s54, s46, s45
    s_lshl_b32 s54, s54, 13
    v_add_u32 v1, s54, v11
    s_mov_b32 s10, 4194304
    s_mov_b32 s11, 0x20000
    s_mov_b32 s60, s2
    s_add_u32 s61, s60, 4096
    s_xor_b32 s62, s60, 0x4000
    s_xor_b32 s63, s61, 0x4000
    s_lshl_b32 s45, s40, 22
    s_waitcnt lgkmcnt(0)
    s_add_u32 s8, s70, s45
    s_addc_u32 s9, s71, 0
    buffer_load_dwordx4 v[128:131], v1, s[8:11], s60 offen offset:0 nt
    buffer_load_dwordx4 v[132:135], v1, s[8:11], s60 offen offset:1024 nt
    buffer_load_dwordx4 v[136:139], v1, s[8:11], s60 offen offset:2048 nt
    buffer_load_dwordx4 v[140:143], v1, s[8:11], s60 offen offset:3072 nt
    buffer_load_dwordx4 v[144:147], v1, s[8:11], s61 offen offset:0 nt
    buffer_load_dwordx4 v[148:151], v1, s[8:11], s61 offen offset:1024 nt
    s_add_u32 s38, s72, s45
    s_addc_u32 s39, s73, 0
    s_lshl_b32 s44, s3, 12
    s_add_u32 m0, s44, 1536
    s_mov_b32 s18, 0x4000
    s_mov_b32 s19, 0x20000
    s_mov_b32 s22, 0x4000
    s_mov_b32 s23, 0x20000
    s_mov_b32 s34, 0x4000
    s_mov_b32 s35, 0x20000
    s_lshl_b32 s55, s40, 14
    s_cmp_eq_u32 s3, 1
    s_cselect_b64 s[16:17], s[76:77], s[74:75]
    s_cmp_eq_u32 s3, 2
    s_cselect_b64 s[16:17], s[78:79], s[16:17]
    s_cmp_eq_u32 s3, 3
    s_cselect_b64 s[16:17], s[80:81], s[16:17]
    s_add_u32 s16, s16, s55
    s_addc_u32 s17, s17, 0
    s_lshl_b32 s45, s41, 12
    buffer_load_dwordx4 v11, s[16:19], s45 offen offset:0 nt lds
    buffer_load_dwordx4 v11, s[16:19], s45 offen offset:1024 nt lds
    buffer_load_dwordx4 v11, s[16:19], s45 offen offset:2048 nt lds
    buffer_load_dwordx4 v11, s[16:19], s45 offen offset:3072 nt lds
    s_add_u32 s20, s68, s55
    s_addc_u32 s21, s69, 0
    v_and_b32 v22, 15, v0
    v_lshrrev_b32 v23, 4, v0
    v_lshlrev_b32_e64 v26, 8, v22
    v_lshl_add_u32 v26, v23, 4, v26
    s_lshl_b32 s45, s3, 12
    buffer_load_dwordx4 v[192:195], v26, s[20:23], s45 offen offset:0
    buffer_load_dwordx4 v[196:199], v26, s[20:23], s45 offen offset:64
    buffer_load_dwordx4 v[200:203], v26, s[20:23], s45 offen offset:128
    buffer_load_dwordx4 v[204:207], v26, s[20:23], s45 offen offset:192
    v_mov_b32 v48, -1
    v_mov_b32 v49, -1
    v_lshlrev_b32_e64 v50, 3, v0
    s_lshl2_add_u32 s46, s40, s3
    s_lshl2_add_u32 s46, s46, s41
    s_lshl_b32 s46, s46, 13
    s_add_u32 s46, s46, 1052672
    s_mov_b32 s30, 0x40000000
    s_mov_b32 s31, 0x20000
    s_mov_b32 s26, 256
    s_mov_b32 s27, 0x20000
    v_mov_b32_e64 v15, 1
    s_mov_b64 s[28:29], s[6:7]
    s_mov_b64 exec, 0xffff
    buffer_store_dwordx2 v[48:49], v50, s[28:31], s46 offen sc0 sc1
    s_mov_b64 exec, -1
    s_mov_b64 s[24:25], s[4:5]
    s_cmp_eq_u32 s3, 0
    s_cselect_b32 s57, 1, 0
    s_or_b32 s45, s59, s3
    s_cselect_b32 s58, 0, 3
    s_cbranch_scc1 L_noel
    s_mov_b64 exec, 1
    buffer_atomic_add v15, off, s[24:27], 0 sc0
    s_mov_b64 exec, -1
L_noel:
    s_add_u32 s32, s82, s55
    s_addc_u32 s33, s83, 0
    v_and_b32 v20, 31, v0
    v_lshrrev_b32 v21, 5, v0
    v_lshlrev_b32 v10, 2, v0
    s_bfe_u32 s53, s60, 0xc0008
    s_andn2_b32 s52, s53, 255
    v_lshlrev_b32 v8, 3, v20
    v_lshrrev_b32 v9, 4, v20
    v_lshlrev_b32 v9, 5, v9
    v_and_b32 v24, 15, v20
    v_add_lshl_u32 v9, v9, v24, 1
    s_lshr_b32 s45, s54, 8
    v_add_u32 v9, s45, v9
    s_lshr_b32 s45, s3, 1
    s_and_b32 s46, s3, 1
    s_mul_i32 s45, s45, 9216
    s_mul_i32 s46, s46, 2304
    s_add_u32 s45, s45, s46
    s_add_u32 s45, s45, 17920
    v_mul_u32_u24 v252, 1152, v21
    v_lshl_add_u32 v252, v20, 3, v252
    v_add_u32 v252, s45, v252
    v_add_u32 v253, 4608, v252
    v_add_u32 v254, 18432, v252
    v_add_u32 v255, 23040, v252
    v_mul_u32_u24 v3, 288, v22
    v_lshl_add_u32 v3, v23, 4, v3
    s_mul_i32 s45, s3, 4640
    s_add_u32 s45, s45, 54784
    v_mul_u32_u24 v6, 2320, v21
    v_lshl_add_u32 v6, v20, 4, v6
    v_add_u32_e64 v6, s45, v6
    v_mul_u32_u24 v7, 2320, v23
    v_and_b32_e64 v24, 3, v22
    v_mul_u32_u24 v24, 576, v24
    v_lshrrev_b32 v25, 2, v22
    v_lshlrev_b32 v25, 5, v25
    v_add3_u32 v7, v7, v24, v25
    v_add_u32 v7, 54784, v7
    s_lshl_b32 s45, s3, 8
    s_add_u32 s46, s45, 256
    v_and_b32 v4, 1, v20
    v_lshlrev_b32 v4, 7, v4
    v_lshrrev_b32 v24, 1, v20
    v_lshl_add_u32 v4, v24, 3, v4
    v_add_u32 v4, s46, v4
    v_lshlrev_b32 v5, 7, v21
    v_add_u32 v5, s46, v5
    v_mov_b32 v2, 0
    s_mov_b32 s50, 16777216
    s_mov_b32 s64, 0x3e0293ee
    s_mov_b32 s65, 0x3e0293ee
    s_mov_b32 s48, 0xff800000
    s_mov_b32 s47, 0xff800000
    s_mov_b32 s49, 0
    s_mov_b32 s59, 0
    s_mov_b32 s83, 0
    s_mov_b32 s42, 0
    s_mov_b32 s43, 0
    s_bfe_u32 s71, s40, 0x10004
    s_bfe_u32 s45, s40, 0x10002
    s_lshl1_add_u32 s71, s71, s45
    s_bfe_u32 s45, s40, 0x10001
    s_lshl1_add_u32 s71, s71, s45
    s_bfe_u32 s82, s40, 0x10005
    s_bfe_u32 s45, s40, 0x10003
    s_lshl1_add_u32 s82, s82, s45
    s_bfe_u32 s45, s40, 0x10000
    s_lshl1_add_u32 s82, s82, s45
    s_mul_i32 s71, s71, 3
    s_add_u32 s71, s71, 8
    s_lshl_b32 s70, 1, s71
    s_add_u32 s70, s70, 1
    s_mov_b32 s56, 4194304
    v_mov_b32 v64, 0
    v_mov_b32 v65, 0
    v_mov_b32 v66, 0
    v_mov_b32 v67, 0
    v_mov_b32 v68, 0
    v_mov_b32 v69, 0
    v_mov_b32 v70, 0
    v_mov_b32 v71, 0
    v_mov_b32 v72, 0
    v_mov_b32 v73, 0
    v_mov_b32 v74, 0
    v_mov_b32 v75, 0
    v_mov_b32 v76, 0
    v_mov_b32 v77, 0
    v_mov_b32 v78, 0
    v_mov_b32 v79, 0
    v_mov_b32 v80, 0
    v_mov_b32 v81, 0
    v_mov_b32 v82, 0
    v_mov_b32 v83, 0
    v_mov_b32 v84, 0
    v_mov_b32 v85, 0
    v_mov_b32 v86, 0
    v_mov_b32 v87, 0
    v_mov_b32 v88, 0
    v_mov_b32 v89, 0
    v_mov_b32 v90, 0
    v_mov_b32 v91, 0
    v_mov_b32 v92, 0
    v_mov_b32 v93, 0
    v_mov_b32 v94, 0
    v_mov_b32 v95, 0
    v_mov_b32 v248, 0
    v_mov_b32 v249, 0
    v_mov_b32 v250, 0
    v_mov_b32_e64 v251, 0
    v_mov_b32 v39, 0x7149f2ca
    v_mov_b32 v16, 0
    v_mov_b32 v17, 0
    v_mov_b32 v38, 0
    s_waitcnt vmcnt(7)
    buffer_load_dwordx4 v[152:155], v1, s[8:11], s61 offen offset:2048 nt
    s_waitcnt vmcnt(7)
    buffer_load_dwordx4 v[156:159], v1, s[8:11], s61 offen offset:3072 nt
    s_waitcnt vmcnt(7)
    buffer_load_dwordx4 v[160:163], v1, s[8:11], s62 offen offset:0 nt
    s_waitcnt vmcnt(7)
    buffer_load_dwordx4 v[164:167], v1, s[8:11], s62 offen offset:1024 nt
    s_waitcnt vmcnt(7)
    buffer_load_dwordx4 v[168:171], v1, s[8:11], s62 offen offset:2048 nt
    s_waitcnt vmcnt(7)
    buffer_load_dwordx4 v[172:175], v1, s[8:11], s62 offen offset:3072 nt
    s_waitcnt vmcnt(7)
    buffer_load_dwordx4 v[176:179], v1, s[8:11], s63 offen offset:0 nt
    s_waitcnt vmcnt(7)
    buffer_load_dwordx4 v[180:183], v1, s[8:11], s63 offen offset:1024 nt
    s_waitcnt vmcnt(7)
    buffer_load_dwordx4 v[184:187], v1, s[8:11], s63 offen offset:2048 nt
    s_waitcnt vmcnt(7)
    buffer_load_dwordx4 v[188:191], v1, s[8:11], s63 offen offset:3072 nt
    s_waitcnt vmcnt(6)
    s_barrier
    v_add_u32 v36, s52, v8
    ds_read_b64 v[28:29], v36 offset:1536
    ds_read_b64 v[30:31], v36 offset:5632
    v_xor_b32_e64 v36, s53, v9
    ds_read_u16 v32, v36 offset:9728
    ds_read_u16 v33, v36 offset:13824
    s_waitcnt lgkmcnt(0)
    v_lshlrev_b32 v18, 16, v32
    v_lshlrev_b32_e64 v19, 16, v33
    v_mul_f32 v19, -v19, v18
    ds_write_b64 v4, v[18:19]
L_K:
    s_add_u32 s42, s42, 1
    s_cmp_lt_u32 s42, 16
    s_cbranch_scc0 L_k2v
    s_lshl_b32 s60, s42, 16
    s_xor_b32 s60, s60, s2
    s_add_u32 s61, s60, 4096
    s_xor_b32 s62, s60, 0x4000
    s_xor_b32 s63, s61, 0x4000
    s_bfe_u32 s52, s60, 0xc0008
    s_andn2_b32 s52, s52, 255
    s_cmp_le_u32 s42, s58
    s_cbranch_scc1 L_hookK
L_k1:
    s_waitcnt lgkmcnt(0)
    v_lshlrev_b32 v20, 16, v28
    v_lshlrev_b32 v24, 16, v30
    v_lshlrev_b32 v22, 16, v29
    v_lshlrev_b32 v26, 16, v31
    v_and_b32 v21, 0xffff0000, v28
    v_and_b32 v25, 0xffff0000, v30
    v_and_b32 v23, 0xffff0000, v29
    v_and_b32 v27, 0xffff0000, v31
    v_pk_mul_f32 v[20:21], v[20:21], s[64:65]
    v_pk_mul_f32 v[22:23], v[22:23], s[64:65]
    v_pk_mul_f32 v[24:25], v[24:25], v[20:21] neg_lo:[1,0] neg_hi:[1,0]
    v_pk_mul_f32 v[26:27], v[26:27], v[22:23] neg_lo:[1,0] neg_hi:[1,0]
    v_cvt_f32_i32 v128, v128
    v_cvt_f32_i32 v129, v129
    v_cvt_f32_i32 v130, v130
    v_cvt_f32_i32 v131, v131
    v_cvt_f32_i32 v132, v132
    v_cvt_f32_i32 v133, v133
    v_cvt_f32_i32 v134, v134
    v_cvt_f32_i32 v135, v135
    v_pk_fma_f32 v[128:129], v[128:129], v[20:21], v[24:25]
    v_pk_fma_f32 v[130:131], v[130:131], v[22:23], v[26:27]
    v_pk_fma_f32 v[132:133], v[132:133], v[20:21], v[24:25]
    v_pk_fma_f32 v[134:135], v[134:135], v[22:23], v[26:27]
    v_cvt_pk_bf16_f32 v40, v128, v129
    v_cvt_pk_bf16_f32 v41, v130, v131
    v_cvt_pk_bf16_f32 v42, v132, v133
    v_cvt_pk_bf16_f32 v43, v134, v135
    s_waitcnt vmcnt(4)
    buffer_load_dwordx4 v[128:131], v1, s[8:11], s60 offen offset:0 nt
    ds_write2_b64 v252, v[40:41], v[42:43] offset0:0 offset1:36
    v_cvt_f32_i32 v136, v136
    v_cvt_f32_i32 v137, v137
    v_cvt_f32_i32 v138, v138
    v_cvt_f32_i32 v139, v139
    v_cvt_f32_i32 v140, v140
    v_cvt_f32_i32 v141, v141
    v_cvt_f32_i32 v142, v142
    v_cvt_f32_i32_e64 v143, v143
    v_pk_fma_f32 v[136:137], v[136:137], v[20:21], v[24:25]
    v_pk_fma_f32 v[138:139], v[138:139], v[22:23], v[26:27]
    v_pk_fma_f32 v[140:141], v[140:141], v[20:21], v[24:25]
    v_pk_fma_f32 v[142:143], v[142:143], v[22:23], v[26:27]
    v_cvt_pk_bf16_f32 v44, v136, v137
    v_cvt_pk_bf16_f32 v45, v138, v139
    v_cvt_pk_bf16_f32 v46, v140, v141
    v_cvt_pk_bf16_f32 v47, v142, v143
    ds_write2_b64 v252, v[44:45], v[46:47] offset0:72 offset1:108
    s_waitcnt vmcnt(4)
    buffer_load_dwordx4 v[132:135], v1, s[8:11], s60 offen offset:1024 nt
    v_cvt_f32_i32 v144, v144
    v_cvt_f32_i32 v145, v145
    v_cvt_f32_i32 v146, v146
    v_cvt_f32_i32 v147, v147
    v_cvt_f32_i32 v148, v148
    v_cvt_f32_i32 v149, v149
    v_cvt_f32_i32 v150, v150
    v_cvt_f32_i32_e64 v151, v151
    v_pk_fma_f32 v[144:145], v[144:145], v[20:21], v[24:25]
    v_pk_fma_f32 v[146:147], v[146:147], v[22:23], v[26:27]
    v_pk_fma_f32 v[148:149], v[148:149], v[20:21], v[24:25]
    v_pk_fma_f32 v[150:151], v[150:151], v[22:23], v[26:27]
    v_cvt_pk_bf16_f32 v40, v144, v145
    v_cvt_pk_bf16_f32 v41, v146, v147
    v_cvt_pk_bf16_f32 v42, v148, v149
    v_cvt_pk_bf16_f32 v43, v150, v151
    ds_write2_b64 v253, v[40:41], v[42:43] offset0:0 offset1:36
    v_cvt_f32_i32 v152, v152
    v_cvt_f32_i32 v153, v153
    v_cvt_f32_i32 v154, v154
    s_waitcnt vmcnt(4)
    buffer_load_dwordx4 v[136:139], v1, s[8:11], s60 offen offset:2048 nt
    v_cvt_f32_i32 v155, v155
    v_cvt_f32_i32 v156, v156
    v_cvt_f32_i32 v157, v157
    v_cvt_f32_i32 v158, v158
    v_cvt_f32_i32_e64 v159, v159
    v_pk_fma_f32 v[152:153], v[152:153], v[20:21], v[24:25]
    v_pk_fma_f32 v[154:155], v[154:155], v[22:23], v[26:27]
    v_pk_fma_f32 v[156:157], v[156:157], v[20:21], v[24:25]
    v_pk_fma_f32 v[158:159], v[158:159], v[22:23], v[26:27]
    v_cvt_pk_bf16_f32 v44, v152, v153
    v_cvt_pk_bf16_f32 v45, v154, v155
    v_cvt_pk_bf16_f32 v46, v156, v157
    v_cvt_pk_bf16_f32 v47, v158, v159
    ds_write2_b64 v253, v[44:45], v[46:47] offset0:72 offset1:108
    v_cvt_f32_i32 v160, v160
    v_cvt_f32_i32 v161, v161
    v_cvt_f32_i32 v162, v162
    v_cvt_f32_i32 v163, v163
    v_cvt_f32_i32 v164, v164
    v_cvt_f32_i32 v165, v165
    v_cvt_f32_i32 v166, v166
    v_cvt_f32_i32_e64 v167, v167
    s_waitcnt vmcnt(4)
    buffer_load_dwordx4 v[140:143], v1, s[8:11], s60 offen offset:3072 nt
    v_pk_fma_f32 v[160:161], v[160:161], v[20:21], v[24:25]
    v_pk_fma_f32 v[162:163], v[162:163], v[22:23], v[26:27]
    v_pk_fma_f32 v[164:165], v[164:165], v[20:21], v[24:25]
    v_pk_fma_f32 v[166:167], v[166:167], v[22:23], v[26:27]
    v_cvt_pk_bf16_f32 v40, v160, v161
    v_cvt_pk_bf16_f32 v41, v162, v163
    v_cvt_pk_bf16_f32 v42, v164, v165
    v_cvt_pk_bf16_f32 v43, v166, v167
    ds_write2_b64 v254, v[40:41], v[42:43] offset0:0 offset1:36
    v_cvt_f32_i32 v168, v168
    v_cvt_f32_i32 v169, v169
    v_cvt_f32_i32 v170, v170
    v_cvt_f32_i32 v171, v171
    v_cvt_f32_i32 v172, v172
    v_cvt_f32_i32 v173, v173
    v_cvt_f32_i32 v174, v174
    v_cvt_f32_i32 v175, v175
    v_pk_fma_f32 v[168:169], v[168:169], v[20:21], v[24:25]
    v_pk_fma_f32 v[170:171], v[170:171], v[22:23], v[26:27]
    v_pk_fma_f32 v[172:173], v[172:173], v[20:21], v[24:25]
    v_pk_fma_f32 v[174:175], v[174:175], v[22:23], v[26:27]
    v_cvt_pk_bf16_f32 v44, v168, v169
    s_waitcnt vmcnt(4)
    buffer_load_dwordx4 v[144:147], v1, s[8:11], s61 offen offset:0 nt
    v_cvt_pk_bf16_f32 v45, v170, v171
    v_cvt_pk_bf16_f32 v46, v172, v173
    v_cvt_pk_bf16_f32 v47, v174, v175
    ds_write2_b64 v254, v[44:45], v[46:47] offset0:72 offset1:108
    v_cvt_f32_i32 v176, v176
    v_cvt_f32_i32 v177, v177
    v_cvt_f32_i32 v178, v178
    v_cvt_f32_i32 v179, v179
    v_cvt_f32_i32 v180, v180
    v_cvt_f32_i32 v181, v181
    v_cvt_f32_i32 v182, v182
    v_cvt_f32_i32_e64 v183, v183
    v_pk_fma_f32 v[176:177], v[176:177], v[20:21], v[24:25]
    v_pk_fma_f32 v[178:179], v[178:179], v[22:23], v[26:27]
    v_pk_fma_f32 v[180:181], v[180:181], v[20:21], v[24:25]
    v_pk_fma_f32 v[182:183], v[182:183], v[22:23], v[26:27]
    v_cvt_pk_bf16_f32 v40, v176, v177
    v_cvt_pk_bf16_f32 v41, v178, v179
    v_cvt_pk_bf16_f32 v42, v180, v181
    v_cvt_pk_bf16_f32 v43, v182, v183
    ds_write2_b64 v255, v[40:41], v[42:43] offset0:0 offset1:36
    s_waitcnt vmcnt(4)
    buffer_load_dwordx4 v[148:151], v1, s[8:11], s61 offen offset:1024 nt
    v_cvt_f32_i32 v184, v184
    v_cvt_f32_i32 v185, v185
    v_cvt_f32_i32 v186, v186
    v_cvt_f32_i32 v187, v187
    v_cvt_f32_i32 v188, v188
    v_cvt_f32_i32 v189, v189
    v_cvt_f32_i32 v190, v190
    v_cvt_f32_i32_e64 v191, v191
    v_pk_fma_f32 v[184:185], v[184:185], v[20:21], v[24:25]
    v_pk_fma_f32 v[186:187], v[186:187], v[22:23], v[26:27]
    v_pk_fma_f32 v[188:189], v[188:189], v[20:21], v[24:25]
    v_pk_fma_f32 v[190:191], v[190:191], v[22:23], v[26:27]
    v_cvt_pk_bf16_f32 v44, v184, v185
    v_cvt_pk_bf16_f32 v45, v186, v187
    v_cvt_pk_bf16_f32 v46, v188, v189
    v_cvt_pk_bf16_f32 v47, v190, v191
    ds_write2_b64 v255, v[44:45], v[46:47] offset0:72 offset1:108
    s_waitcnt vmcnt(4)
    buffer_load_dwordx4 v[152:155], v1, s[8:11], s61 offen offset:2048 nt
    s_branch L_save
L_saved:
    buffer_load_dwordx4 v[156:159], v1, s[8:11], s61 offen offset:3072 nt
    s_waitcnt lgkmcnt(0)
    s_barrier
    ds_read_b128 v[208:211], v3 offset:17920
    ds_read_b128 v[212:215], v3 offset:22528
    ds_read_b128 v[216:219], v3 offset:17984
    ds_read_b128 v[220:223], v3 offset:22592
    ds_read_b128 v[224:227], v3 offset:18048
    ds_read_b128 v[228:231], v3 offset:22656
    ds_read_b128 v[232:235], v3 offset:18112
    ds_read_b128 v[236:239], v3 offset:22720
    s_waitcnt lgkmcnt(6)
    v_mfma_f32_16x16x32_bf16 v[96:99], v[208:211], v[192:195], v[248:251]
    ds_read_b128 v[240:243], v3 offset:27136
    v_mfma_f32_16x16x32_bf16 v[100:103], v[212:215], v[192:195], v[248:251]
    ds_read_b128 v[244:247], v3 offset:31744
    s_waitcnt lgkmcnt(6)
    v_mfma_f32_16x16x32_bf16 v[96:99], v[216:219], v[196:199], v[96:99]
    s_waitcnt vmcnt(4)
    buffer_load_dwordx4 v[160:163], v1, s[8:11], s62 offen offset:0 nt
    ds_read_b128 v[208:211], v3 offset:27200
    v_mfma_f32_16x16x32_bf16 v[100:103], v[220:223], v[196:199], v[100:103]
    ds_read_b128 v[212:215], v3 offset:31808
    s_waitcnt lgkmcnt(6)
    v_mfma_f32_16x16x32_bf16 v[96:99], v[224:227], v[200:203], v[96:99]
    ds_read_b128 v[216:219], v3 offset:27264
    v_mfma_f32_16x16x32_bf16 v[100:103], v[228:231], v[200:203], v[100:103]
    ds_read_b128 v[220:223], v3 offset:31872
    s_waitcnt lgkmcnt(6)
    v_mfma_f32_16x16x32_bf16 v[96:99], v[232:235], v[204:207], v[96:99]
    ds_read_b128 v[224:227], v3 offset:27328
    v_mfma_f32_16x16x32_bf16 v[100:103], v[236:239], v[204:207], v[100:103]
    ds_read_b128 v[228:231], v3 offset:31936
    s_waitcnt lgkmcnt(6)
    v_mfma_f32_16x16x32_bf16 v[104:107], v[240:243], v[192:195], v[248:251]
    ds_read_b128 v[232:235], v3 offset:36352
    v_mfma_f32_16x16x32_bf16 v[108:111], v[244:247], v[192:195], v[248:251]
    ds_read_b128 v[236:239], v3 offset:40960
    s_waitcnt lgkmcnt(6)
    v_mfma_f32_16x16x32_bf16 v[104:107], v[208:211], v[196:199], v[104:107]
    ds_read_b128 v[240:243], v3 offset:36416
    v_mfma_f32_16x16x32_bf16 v[108:111], v[212:215], v[196:199], v[108:111]
    s_waitcnt vmcnt(4)
    buffer_load_dwordx4 v[164:167], v1, s[8:11], s62 offen offset:1024 nt
    ds_read_b128 v[244:247], v3 offset:41024
    v_max3_f32 v37, v96, v97, v98
    s_waitcnt lgkmcnt(6)
    v_mfma_f32_16x16x32_bf16 v[104:107], v[216:219], v[200:203], v[104:107]
    ds_read_b128 v[208:211], v3 offset:36480
    v_mfma_f32_16x16x32_bf16 v[108:111], v[220:223], v[200:203], v[108:111]
    ds_read_b128 v[212:215], v3 offset:41088
    v_max3_f32 v37, v37, v99, v100
    s_waitcnt lgkmcnt(6)
    v_mfma_f32_16x16x32_bf16 v[104:107], v[224:227], v[204:207], v[104:107]
    ds_read_b128 v[216:219], v3 offset:36544
    v_mfma_f32_16x16x32_bf16 v[108:111], v[228:231], v[204:207], v[108:111]
    ds_read_b128 v[220:223], v3 offset:41152
    v_max3_f32 v37, v37, v101, v102
    v_max_f32 v37, v37, v103
    s_waitcnt lgkmcnt(6)
    v_mfma_f32_16x16x32_bf16 v[112:115], v[232:235], v[192:195], v[248:251]
    ds_read_b128 v[224:227], v3 offset:45568
    v_mfma_f32_16x16x32_bf16 v[116:119], v[236:239], v[192:195], v[248:251]
    ds_read_b128 v[228:231], v3 offset:50176
    s_waitcnt lgkmcnt(6)
    v_mfma_f32_16x16x32_bf16 v[112:115], v[240:243], v[196:199], v[112:115]
    ds_read_b128 v[232:235], v3 offset:45632
    s_waitcnt vmcnt(4)
    buffer_load_dwordx4 v[168:171], v1, s[8:11], s62 offen offset:2048 nt
    v_mfma_f32_16x16x32_bf16 v[116:119], v[244:247], v[196:199], v[116:119]
    ds_read_b128 v[236:239], v3 offset:50240
    v_max3_f32 v37, v37, v104, v105
    s_waitcnt lgkmcnt(6)
    v_mfma_f32_16x16x32_bf16 v[112:115], v[208:211], v[200:203], v[112:115]
    ds_read_b128 v[240:243], v3 offset:45696
    v_mfma_f32_16x16x32_bf16 v[116:119], v[212:215], v[200:203], v[116:119]
    ds_read_b128 v[244:247], v3 offset:50304
    v_max3_f32 v37, v37, v106, v107
    s_waitcnt lgkmcnt(6)
    v_mfma_f32_16x16x32_bf16 v[112:115], v[216:219], v[204:207], v[112:115]
    ds_read_b128 v[208:211], v3 offset:45760
    v_mfma_f32_16x16x32_bf16 v[116:119], v[220:223], v[204:207], v[116:119]
    ds_read_b128 v[212:215], v3 offset:50368
    v_max3_f32 v37, v37, v108, v109
    v_max3_f32 v37, v37, v110, v111
    s_waitcnt lgkmcnt(6)
    v_mfma_f32_16x16x32_bf16 v[120:123], v[224:227], v[192:195], v[248:251]
    v_mfma_f32_16x16x32_bf16 v[124:127], v[228:231], v[192:195], v[248:251]
    s_waitcnt lgkmcnt(4)
    v_mfma_f32_16x16x32_bf16 v[120:123], v[232:235], v[196:199], v[120:123]
    v_mfma_f32_16x16x32_bf16 v[124:127], v[236:239], v[196:199], v[124:127]
    s_waitcnt vmcnt(4)
    buffer_load_dwordx4 v[172:175], v1, s[8:11], s62 offen offset:3072 nt
    s_waitcnt lgkmcnt(2)
    v_mfma_f32_16x16x32_bf16 v[120:123], v[240:243], v[200:203], v[120:123]
    v_max3_f32 v37, v37, v112, v113
    v_mfma_f32_16x16x32_bf16 v[124:127], v[244:247], v[200:203], v[124:127]
    v_max3_f32 v37, v37, v114, v115
    s_waitcnt lgkmcnt(0)
    v_mfma_f32_16x16x32_bf16 v[120:123], v[208:211], v[204:207], v[120:123]
    v_max3_f32 v37, v37, v116, v117
    v_mfma_f32_16x16x32_bf16 v[124:127], v[212:215], v[204:207], v[124:127]
    v_max3_f32 v37, v37, v118, v119
    s_barrier
    v_add_u32_e64 v36, s52, v8
    ds_read_b64 v[28:29], v36 offset:1536
    ds_read_b64 v[30:31], v36 offset:5632
    s_nop 2
    v_max3_f32 v37, v37, v120, v121
    v_max3_f32 v37, v37, v122, v123
    v_max3_f32 v37, v37, v124, v125
    v_max3_f32 v37, v37, v126, v127
    v_cmp_lt_f32 vcc, s48, v37
    s_cbranch_vccnz L_rescaleK
L_rescaledK:
    v_exp_f32_e64 v96, v96
    s_waitcnt vmcnt(4)
    buffer_load_dwordx4 v[176:179], v1, s[8:11], s63 offen offset:0 nt
    v_exp_f32 v97, v97
    v_exp_f32 v98, v98
    v_exp_f32 v99, v99
    v_exp_f32 v100, v100
    v_exp_f32 v101, v101
    v_exp_f32 v102, v102
    v_exp_f32 v103, v103
    v_exp_f32 v104, v104
    v_exp_f32 v105, v105
    v_exp_f32 v106, v106
    v_exp_f32 v107, v107
    v_exp_f32 v108, v108
    v_exp_f32 v109, v109
    v_exp_f32 v110, v110
    v_exp_f32_e64 v111, v111
    v_pk_add_f32 v[16:17], v[16:17], v[96:97]
    s_waitcnt vmcnt(4)
    buffer_load_dwordx4 v[180:183], v1, s[8:11], s63 offen offset:1024 nt
    v_cvt_pk_bf16_f32 v96, v96, v97
    v_pk_add_f32 v[16:17], v[16:17], v[98:99]
    v_cvt_pk_bf16_f32 v97, v98, v99
    v_pk_add_f32 v[16:17], v[16:17], v[100:101]
    v_cvt_pk_bf16_f32 v98, v100, v101
    v_pk_add_f32 v[16:17], v[16:17], v[102:103]
    v_cvt_pk_bf16_f32 v99, v102, v103
    v_pk_add_f32 v[16:17], v[16:17], v[104:105]
    v_cvt_pk_bf16_f32 v100, v104, v105
    v_pk_add_f32 v[16:17], v[16:17], v[106:107]
    v_cvt_pk_bf16_f32 v101, v106, v107
    v_pk_add_f32 v[16:17], v[16:17], v[108:109]
    v_cvt_pk_bf16_f32 v102, v108, v109
    v_pk_add_f32 v[16:17], v[16:17], v[110:111]
    v_cvt_pk_bf16_f32 v103, v110, v111
    v_exp_f32 v112, v112
    v_exp_f32 v113, v113
    v_exp_f32 v114, v114
    v_exp_f32 v115, v115
    v_exp_f32 v116, v116
    v_exp_f32 v117, v117
    v_exp_f32 v118, v118
    v_exp_f32 v119, v119
    s_waitcnt vmcnt(4)
    buffer_load_dwordx4 v[184:187], v1, s[8:11], s63 offen offset:2048 nt
    v_exp_f32 v120, v120
    v_exp_f32 v121, v121
    v_exp_f32 v122, v122
    v_exp_f32 v123, v123
    v_exp_f32 v124, v124
    v_exp_f32 v125, v125
    v_exp_f32 v126, v126
    v_exp_f32 v127, v127
    v_pk_add_f32 v[16:17], v[16:17], v[112:113]
    v_cvt_pk_bf16_f32 v104, v112, v113
    v_pk_add_f32 v[16:17], v[16:17], v[114:115]
    v_cvt_pk_bf16_f32 v105, v114, v115
    v_pk_add_f32 v[16:17], v[16:17], v[116:117]
    v_cvt_pk_bf16_f32 v106, v116, v117
    v_pk_add_f32 v[16:17], v[16:17], v[118:119]
    v_cvt_pk_bf16_f32 v107, v118, v119
    v_pk_add_f32 v[16:17], v[16:17], v[120:121]
    v_cvt_pk_bf16_f32 v108, v120, v121
    v_pk_add_f32 v[16:17], v[16:17], v[122:123]
    v_cvt_pk_bf16_f32 v109, v122, v123
    v_pk_add_f32 v[16:17], v[16:17], v[124:125]
    v_cvt_pk_bf16_f32 v110, v124, v125
    buffer_load_dwordx4 v[188:191], v1, s[8:11], s63 offen offset:3072 nt
    v_pk_add_f32 v[16:17], v[16:17], v[126:127]
    v_cvt_pk_bf16_f32 v111, v126, v127
    s_cmp_lt_u32 s42, 16
    s_cbranch_scc1 L_K
    ds_read_b128 v[112:115], v5 offset:0
    ds_read_b128 v[116:119], v5 offset:16
    ds_read_b128 v[120:123], v5 offset:32
    ds_read_b128 v[124:127], v5 offset:48
    v_mov_b32 v192, v96
    v_mov_b32 v193, v97
    v_mov_b32 v194, v98
    v_mov_b32 v195, v99
    v_mov_b32 v196, v100
    v_mov_b32 v197, v101
    v_mov_b32 v198, v102
    v_mov_b32 v199, v103
    v_mov_b32 v200, v104
    v_mov_b32 v201, v105
    v_mov_b32 v202, v106
    v_mov_b32 v203, v107
    v_mov_b32 v204, v108
    v_mov_b32 v205, v109
    v_mov_b32 v206, v110
    v_mov_b32 v207, v111
    v_add_f32 v13, v16, v17
    v_mov_b32 v35, v13
    s_nop 1
    v_permlane32_swap_b32 v35, v13
    s_nop 1
    v_add_f32 v13, v13, v35
    v_mov_b32 v35, v13
    s_nop 1
    v_permlane16_swap_b32 v35, v13
    s_nop 1
    v_add_f32 v13, v13, v35
L_V:
    s_add_u32 s43, s43, 1
    s_bitcmp1_b32 0x1d868, s43
    s_waitcnt lgkmcnt(0)
    s_cbranch_scc1 L_ctl
L_v0:
    s_lshl_b32 s60, s43, 16
    s_xor_b32 s60, s60, s2
    s_add_u32 s61, s60, 4096
    s_xor_b32 s62, s60, 0x4000
    s_xor_b32 s63, s61, 0x4000
    s_bfe_u32 s53, s60, 0xc0008
    s_cmp_lg_u32 s59, 0
    s_cbranch_scc1 L_vdisp
L_V_:
    v_cvt_f32_i32 v128, v128
    v_cvt_f32_i32 v129, v129
    v_cvt_f32_i32 v130, v130
    v_cvt_f32_i32 v131, v131
    v_cvt_f32_i32 v132, v132
    v_cvt_f32_i32 v133, v133
    v_cvt_f32_i32 v134, v134
    v_cvt_f32_i32 v135, v135
    v_pk_fma_f32 v[128:129], v[128:129], v[112:113], v[112:113] op_sel:[0,0,1] op_sel_hi:[1,0,1]
    v_pk_fma_f32 v[130:131], v[130:131], v[112:113], v[112:113] op_sel:[0,0,1] op_sel_hi:[1,0,1]
    v_pk_fma_f32 v[132:133], v[132:133], v[114:115], v[114:115] op_sel:[0,0,1] op_sel_hi:[1,0,1]
    v_pk_fma_f32 v[134:135], v[134:135], v[114:115], v[114:115] op_sel:[0,0,1] op_sel_hi:[1,0,1]
    ds_read_b128 v[112:115], v5 offset:64
    v_cvt_pk_bf16_f32 v48, v128, v132
    v_cvt_pk_bf16_f32 v52, v129, v133
    v_cvt_pk_bf16_f32 v56, v130, v134
    v_cvt_pk_bf16_f32 v60, v131, v135
    s_waitcnt vmcnt(4)
    buffer_load_dwordx4 v[128:131], v1, s[8:11], s60 offen offset:0 nt
    v_cvt_f32_i32 v136, v136
    v_cvt_f32_i32 v137, v137
    v_cvt_f32_i32 v138, v138
    v_cvt_f32_i32 v139, v139
    v_cvt_f32_i32 v140, v140
    v_cvt_f32_i32 v141, v141
    v_cvt_f32_i32 v142, v142
    v_cvt_f32_i32_e64 v143, v143
    v_pk_fma_f32 v[136:137], v[136:137], v[116:117], v[116:117] op_sel:[0,0,1] op_sel_hi:[1,0,1]
    v_pk_fma_f32 v[138:139], v[138:139], v[116:117], v[116:117] op_sel:[0,0,1] op_sel_hi:[1,0,1]
    v_pk_fma_f32 v[140:141], v[140:141], v[118:119], v[118:119] op_sel:[0,0,1] op_sel_hi:[1,0,1]
    v_pk_fma_f32 v[142:143], v[142:143], v[118:119], v[118:119] op_sel:[0,0,1] op_sel_hi:[1,0,1]
    ds_read_b128 v[116:119], v5 offset:80
    v_cvt_pk_bf16_f32 v49, v136, v140
    v_cvt_pk_bf16_f32 v53, v137, v141
    v_cvt_pk_bf16_f32 v57, v138, v142
    v_cvt_pk_bf16_f32 v61, v139, v143
    v_cvt_f32_i32 v144, v144
    v_cvt_f32_i32 v145, v145
    v_cvt_f32_i32 v148, v148
    v_cvt_f32_i32 v149, v149
    v_cvt_f32_i32 v152, v152
    s_waitcnt vmcnt(4)
    buffer_load_dwordx4 v[132:135], v1, s[8:11], s60 offen offset:1024 nt
    v_cvt_f32_i32 v153, v153
    v_cvt_f32_i32 v156, v156
    v_cvt_f32_i32_e64 v157, v157
    v_pk_fma_f32 v[144:145], v[144:145], v[120:121], v[120:121] op_sel:[0,0,1] op_sel_hi:[1,0,1]
    v_pk_fma_f32 v[148:149], v[148:149], v[122:123], v[122:123] op_sel:[0,0,1] op_sel_hi:[1,0,1]
    v_pk_fma_f32 v[152:153], v[152:153], v[124:125], v[124:125] op_sel:[0,0,1] op_sel_hi:[1,0,1]
    v_pk_fma_f32 v[156:157], v[156:157], v[126:127], v[126:127] op_sel:[0,0,1] op_sel_hi:[1,0,1]
    v_cvt_pk_bf16_f32 v50, v144, v148
    v_cvt_pk_bf16_f32 v51, v152, v156
    ds_write_b128 v6, v[48:51] offset:0
    v_cvt_f32_i32 v146, v146
    v_cvt_f32_i32 v147, v147
    v_cvt_f32_i32 v150, v150
    v_cvt_f32_i32 v151, v151
    v_cvt_f32_i32 v154, v154
    v_cvt_f32_i32 v155, v155
    v_cvt_f32_i32 v158, v158
    v_cvt_f32_i32_e64 v159, v159
    s_waitcnt vmcnt(4)
    buffer_load_dwordx4 v[136:139], v1, s[8:11], s60 offen offset:2048 nt
    v_cvt_pk_bf16_f32 v54, v145, v149
    v_cvt_pk_bf16_f32 v55, v153, v157
    ds_write_b128 v6, v[52:55] offset:576
    v_pk_fma_f32 v[146:147], v[146:147], v[120:121], v[120:121] op_sel:[0,0,1] op_sel_hi:[1,0,1]
    v_pk_fma_f32 v[150:151], v[150:151], v[122:123], v[122:123] op_sel:[0,0,1] op_sel_hi:[1,0,1]
    v_pk_fma_f32 v[154:155], v[154:155], v[124:125], v[124:125] op_sel:[0,0,1] op_sel_hi:[1,0,1]
    v_pk_fma_f32 v[158:159], v[158:159], v[126:127], v[126:127] op_sel:[0,0,1] op_sel_hi:[1,0,1]
    v_cvt_pk_bf16_f32 v58, v146, v150
    v_cvt_pk_bf16_f32 v59, v154, v158
    ds_write_b128 v6, v[56:59] offset:1152
    v_cvt_pk_bf16_f32 v62, v147, v151
    v_cvt_pk_bf16_f32 v63, v155, v159
    s_waitcnt vmcnt(4)
    buffer_load_dwordx4 v[140:143], v1, s[8:11], s60 offen offset:3072 nt
    ds_write_b128 v6, v[60:63] offset:1728
    ds_read_b128 v[120:123], v5 offset:96
    ds_read_b128 v[124:127], v5 offset:112
    v_xor_b32 v36, s53, v9
    ds_read_u16 v32, v36 offset:9728
    ds_read_u16 v33, v36 offset:13824
    s_branch L_restore
L_restored:
    s_cmp_lg_u32 s59, 0
    s_cbranch_scc1 L_rdisp
L_rest_:
    s_waitcnt vmcnt(4)
    buffer_load_dwordx4 v[144:147], v1, s[8:11], s61 offen offset:0 nt
    s_cmp_lg_u32 s49, 0
    s_cbranch_scc0 L_noat
    s_mov_b64 exec, 1
    v_mov_b32 v38, s70
    buffer_atomic_add v38, off, s[28:31], s50 sc0
    s_mov_b64 exec, -1
L_noat:
    s_waitcnt vmcnt(4)
    buffer_load_dwordx4 v[148:151], v1, s[8:11], s61 offen offset:1024 nt
    s_waitcnt lgkmcnt(0)
    s_barrier
    ds_read_b128 v[208:211], v7 offset:0
    ds_read_b128 v[212:215], v7 offset:16
    ds_read_b128 v[216:219], v7 offset:128
    ds_read_b128 v[220:223], v7 offset:144
    ds_read_b128 v[224:227], v7 offset:256
    ds_read_b128 v[228:231], v7 offset:272
    ds_read_b128 v[232:235], v7 offset:384
    ds_read_b128 v[236:239], v7 offset:400
    v_lshlrev_b32 v18, 16, v32
    v_lshlrev_b32 v19, 16, v33
    v_mul_f32 v19, -v19, v18
    s_waitcnt lgkmcnt(6)
    v_mfma_f32_16x16x32_bf16 v[64:67], v[208:211], v[96:99], v[64:67]
    ds_read_b128 v[240:243], v7 offset:9280
    s_waitcnt vmcnt(4)
    buffer_load_dwordx4 v[152:155], v1, s[8:11], s61 offen offset:2048 nt
    v_mfma_f32_16x16x32_bf16 v[68:71], v[212:215], v[96:99], v[68:71]
    ds_read_b128 v[244:247], v7 offset:9296
    s_waitcnt lgkmcnt(6)
    v_mfma_f32_16x16x32_bf16 v[72:75], v[216:219], v[96:99], v[72:75]
    ds_read_b128 v[208:211], v7 offset:9408
    v_mfma_f32_16x16x32_bf16 v[76:79], v[220:223], v[96:99], v[76:79]
    ds_read_b128 v[212:215], v7 offset:9424
    s_waitcnt lgkmcnt(6)
    v_mfma_f32_16x16x32_bf16 v[80:83], v[224:227], v[96:99], v[80:83]
    ds_read_b128 v[216:219], v7 offset:9536
    v_mfma_f32_16x16x32_bf16 v[84:87], v[228:231], v[96:99], v[84:87]
    ds_read_b128 v[220:223], v7 offset:9552
    s_waitcnt lgkmcnt(6)
    v_mfma_f32_16x16x32_bf16 v[88:91], v[232:235], v[96:99], v[88:91]
    ds_read_b128 v[224:227], v7 offset:9664
    v_mfma_f32_16x16x32_bf16 v[92:95], v[236:239], v[96:99], v[92:95]
    s_waitcnt vmcnt(4)
    buffer_load_dwordx4 v[156:159], v1, s[8:11], s61 offen offset:3072 nt
    ds_read_b128 v[228:231], v7 offset:9680
    s_waitcnt lgkmcnt(6)
    v_mfma_f32_16x16x32_bf16 v[64:67], v[240:243], v[100:103], v[64:67]
    v_mfma_f32_16x16x32_bf16 v[68:71], v[244:247], v[100:103], v[68:71]
    ds_write_b64 v4, v[18:19]
    s_waitcnt lgkmcnt(5)
    v_mfma_f32_16x16x32_bf16 v[72:75], v[208:211], v[100:103], v[72:75]
    v_mfma_f32_16x16x32_bf16 v[76:79], v[212:215], v[100:103], v[76:79]
    s_waitcnt lgkmcnt(3)
    v_mfma_f32_16x16x32_bf16 v[80:83], v[216:219], v[100:103], v[80:83]
    v_mfma_f32_16x16x32_bf16 v[84:87], v[220:223], v[100:103], v[84:87]
    s_waitcnt lgkmcnt(1)
    v_mfma_f32_16x16x32_bf16 v[88:91], v[224:227], v[100:103], v[88:91]
    v_mfma_f32_16x16x32_bf16 v[92:95], v[228:231], v[100:103], v[92:95]
    v_cvt_f32_i32 v160, v160
    v_cvt_f32_i32 v161, v161
    v_cvt_f32_i32 v162, v162
    v_cvt_f32_i32 v163, v163
    v_cvt_f32_i32 v164, v164
    v_cvt_f32_i32 v165, v165
    v_cvt_f32_i32 v166, v166
    v_cvt_f32_i32 v167, v167
    v_pk_fma_f32 v[160:161], v[160:161], v[112:113], v[112:113] op_sel:[0,0,1] op_sel_hi:[1,0,1]
    v_pk_fma_f32 v[162:163], v[162:163], v[112:113], v[112:113] op_sel:[0,0,1] op_sel_hi:[1,0,1]
    v_pk_fma_f32 v[164:165], v[164:165], v[114:115], v[114:115] op_sel:[0,0,1] op_sel_hi:[1,0,1]
    v_pk_fma_f32 v[166:167], v[166:167], v[114:115], v[114:115] op_sel:[0,0,1] op_sel_hi:[1,0,1]
    v_cvt_pk_bf16_f32 v48, v160, v164
    v_cvt_pk_bf16_f32 v52, v161, v165
    v_cvt_pk_bf16_f32 v56, v162, v166
    v_cvt_pk_bf16_f32 v60, v163, v167
    s_waitcnt vmcnt(4)
    buffer_load_dwordx4 v[160:163], v1, s[8:11], s62 offen offset:0 nt
    v_cvt_f32_i32 v168, v168
    v_cvt_f32_i32 v169, v169
    v_cvt_f32_i32 v170, v170
    v_cvt_f32_i32 v171, v171
    v_cvt_f32_i32 v172, v172
    v_cvt_f32_i32 v173, v173
    s_waitcnt vmcnt(4)
    buffer_load_dwordx4 v[164:167], v1, s[8:11], s62 offen offset:1024 nt
    v_cvt_f32_i32 v174, v174
    v_cvt_f32_i32 v175, v175
    v_pk_fma_f32 v[168:169], v[168:169], v[116:117], v[116:117] op_sel:[0,0,1] op_sel_hi:[1,0,1]
    v_pk_fma_f32 v[170:171], v[170:171], v[116:117], v[116:117] op_sel:[0,0,1] op_sel_hi:[1,0,1]
    v_pk_fma_f32 v[172:173], v[172:173], v[118:119], v[118:119] op_sel:[0,0,1] op_sel_hi:[1,0,1]
    v_pk_fma_f32 v[174:175], v[174:175], v[118:119], v[118:119] op_sel:[0,0,1] op_sel_hi:[1,0,1]
    v_cvt_pk_bf16_f32 v49, v168, v172
    v_cvt_pk_bf16_f32 v53, v169, v173
    v_cvt_pk_bf16_f32 v57, v170, v174
    v_cvt_pk_bf16_f32 v61, v171, v175
    v_cvt_f32_i32 v176, v176
    v_cvt_f32_i32 v177, v177
    v_cvt_f32_i32 v180, v180
    v_cvt_f32_i32 v181, v181
    v_cvt_f32_i32 v184, v184
    v_cvt_f32_i32 v185, v185
    v_cvt_f32_i32 v188, v188
    v_cvt_f32_i32 v189, v189
    v_pk_fma_f32 v[176:177], v[176:177], v[120:121], v[120:121] op_sel:[0,0,1] op_sel_hi:[1,0,1]
    v_pk_fma_f32 v[180:181], v[180:181], v[122:123], v[122:123] op_sel:[0,0,1] op_sel_hi:[1,0,1]
    v_pk_fma_f32 v[184:185], v[184:185], v[124:125], v[124:125] op_sel:[0,0,1] op_sel_hi:[1,0,1]
    v_pk_fma_f32 v[188:189], v[188:189], v[126:127], v[126:127] op_sel:[0,0,1] op_sel_hi:[1,0,1]
    v_cvt_pk_bf16_f32 v50, v176, v180
    v_cvt_pk_bf16_f32 v51, v184, v188
    s_waitcnt vmcnt(4)
    buffer_load_dwordx4 v[168:171], v1, s[8:11], s62 offen offset:2048 nt
    ds_write_b128 v6, v[48:51] offset:18560
    v_cvt_f32_i32 v178, v178
    v_cvt_f32_i32 v179, v179
    v_cvt_f32_i32 v182, v182
    v_cvt_f32_i32 v183, v183
    v_cvt_f32_i32 v186, v186
    v_cvt_f32_i32 v187, v187
    v_cvt_f32_i32 v190, v190
    v_cvt_f32_i32_e64 v191, v191
    v_cvt_pk_bf16_f32 v54, v177, v181
    v_cvt_pk_bf16_f32 v55, v185, v189
    ds_write_b128 v6, v[52:55] offset:19136
    s_waitcnt vmcnt(4)
    buffer_load_dwordx4 v[172:175], v1, s[8:11], s62 offen offset:3072 nt
    v_pk_fma_f32 v[178:179], v[178:179], v[120:121], v[120:121] op_sel:[0,0,1] op_sel_hi:[1,0,1]
    v_pk_fma_f32 v[182:183], v[182:183], v[122:123], v[122:123] op_sel:[0,0,1] op_sel_hi:[1,0,1]
    v_pk_fma_f32 v[186:187], v[186:187], v[124:125], v[124:125] op_sel:[0,0,1] op_sel_hi:[1,0,1]
    v_pk_fma_f32 v[190:191], v[190:191], v[126:127], v[126:127] op_sel:[0,0,1] op_sel_hi:[1,0,1]
    v_cvt_pk_bf16_f32 v58, v178, v182
    v_cvt_pk_bf16_f32 v59, v186, v190
    ds_write_b128 v6, v[56:59] offset:19712
    v_cvt_pk_bf16_f32 v62, v179, v183
    v_cvt_pk_bf16_f32 v63, v187, v191
    ds_write_b128 v6, v[60:63] offset:20288
    s_cmp_lg_u32 s49, 0
    s_cbranch_scc0 L_nopost
    s_waitcnt vmcnt(7)
    ds_write_b32 v10, v38 offset:0
L_nopost:
    s_waitcnt vmcnt(4)
    buffer_load_dwordx4 v[176:179], v1, s[8:11], s63 offen offset:0 nt
    s_waitcnt lgkmcnt(0)
    s_barrier
    ds_read_b128 v[208:211], v7 offset:18560
    s_waitcnt vmcnt(4)
    buffer_load_dwordx4 v[180:183], v1, s[8:11], s63 offen offset:1024 nt
    ds_read_b128 v[212:215], v7 offset:18576
    ds_read_b128 v[216:219], v7 offset:18688
    ds_read_b128 v[220:223], v7 offset:18704
    ds_read_b128 v[224:227], v7 offset:18816
    ds_read_b128 v[228:231], v7 offset:18832
    ds_read_b128 v[232:235], v7 offset:18944
    ds_read_b128 v[236:239], v7 offset:18960
    s_waitcnt lgkmcnt(6)
    v_mfma_f32_16x16x32_bf16 v[64:67], v[208:211], v[104:107], v[64:67]
    ds_read_b128 v[240:243], v7 offset:27840
    v_mfma_f32_16x16x32_bf16 v[68:71], v[212:215], v[104:107], v[68:71]
    ds_read_b128 v[244:247], v7 offset:27856
    s_waitcnt lgkmcnt(6)
    v_mfma_f32_16x16x32_bf16 v[72:75], v[216:219], v[104:107], v[72:75]
    ds_read_b128 v[208:211], v7 offset:27968
    v_mfma_f32_16x16x32_bf16 v[76:79], v[220:223], v[104:107], v[76:79]
    ds_read_b128 v[212:215], v7 offset:27984
    s_waitcnt lgkmcnt(6)
    v_mfma_f32_16x16x32_bf16 v[80:83], v[224:227], v[104:107], v[80:83]
    s_waitcnt vmcnt(4)
    buffer_load_dwordx4 v[184:187], v1, s[8:11], s63 offen offset:2048 nt
    ds_read_b128 v[216:219], v7 offset:28096
    v_mfma_f32_16x16x32_bf16 v[84:87], v[228:231], v[104:107], v[84:87]
    ds_read_b128 v[220:223], v7 offset:28112
    s_waitcnt lgkmcnt(6)
    v_mfma_f32_16x16x32_bf16 v[88:91], v[232:235], v[104:107], v[88:91]
    ds_read_b128 v[224:227], v7 offset:28224
    v_mfma_f32_16x16x32_bf16 v[92:95], v[236:239], v[104:107], v[92:95]
    ds_read_b128 v[228:231], v7 offset:28240
    s_waitcnt lgkmcnt(6)
    v_mfma_f32_16x16x32_bf16 v[64:67], v[240:243], v[108:111], v[64:67]
    ds_read_b128 v[112:115], v5 offset:0
    v_mfma_f32_16x16x32_bf16 v[68:71], v[244:247], v[108:111], v[68:71]
    ds_read_b128 v[116:119], v5 offset:16
    s_waitcnt lgkmcnt(6)
    v_mfma_f32_16x16x32_bf16 v[72:75], v[208:211], v[108:111], v[72:75]
    ds_read_b128 v[120:123], v5 offset:32
    v_mfma_f32_16x16x32_bf16 v[76:79], v[212:215], v[108:111], v[76:79]
    buffer_load_dwordx4 v[188:191], v1, s[8:11], s63 offen offset:3072 nt
    ds_read_b128 v[124:127], v5 offset:48
    s_waitcnt lgkmcnt(6)
    v_mfma_f32_16x16x32_bf16 v[80:83], v[216:219], v[108:111], v[80:83]
    ds_read_b32 v34, v2
    v_mfma_f32_16x16x32_bf16 v[84:87], v[220:223], v[108:111], v[84:87]
    s_waitcnt lgkmcnt(5)
    v_mfma_f32_16x16x32_bf16 v[88:91], v[224:227], v[108:111], v[88:91]
    v_mfma_f32_16x16x32_bf16 v[92:95], v[228:231], v[108:111], v[92:95]
    s_branch L_V
L_Vf_:
    v_cvt_f32_i32 v128, v128
    v_cvt_f32_i32 v129, v129
    v_cvt_f32_i32 v130, v130
    v_cvt_f32_i32 v131, v131
    v_cvt_f32_i32 v132, v132
    v_cvt_f32_i32 v133, v133
    v_cvt_f32_i32 v134, v134
    v_cvt_f32_i32 v135, v135
    v_pk_fma_f32 v[128:129], v[128:129], v[112:113], v[112:113] op_sel:[0,0,1] op_sel_hi:[1,0,1]
    v_pk_fma_f32 v[130:131], v[130:131], v[112:113], v[112:113] op_sel:[0,0,1] op_sel_hi:[1,0,1]
    v_pk_fma_f32 v[132:133], v[132:133], v[114:115], v[114:115] op_sel:[0,0,1] op_sel_hi:[1,0,1]
    v_pk_fma_f32 v[134:135], v[134:135], v[114:115], v[114:115] op_sel:[0,0,1] op_sel_hi:[1,0,1]
    ds_read_b128 v[112:115], v5 offset:64
    v_cvt_pk_bf16_f32 v48, v128, v132
    v_cvt_pk_bf16_f32 v52, v129, v133
    v_cvt_pk_bf16_f32 v56, v130, v134
    v_cvt_pk_bf16_f32 v60, v131, v135
    s_waitcnt vmcnt(6)
    buffer_load_dwordx4 v[128:131], v1, s[8:11], s60 offen offset:0 nt
    v_cvt_f32_i32 v136, v136
    v_cvt_f32_i32 v137, v137
    v_cvt_f32_i32 v138, v138
    v_cvt_f32_i32 v139, v139
    v_cvt_f32_i32 v140, v140
    v_cvt_f32_i32 v141, v141
    v_cvt_f32_i32 v142, v142
    v_cvt_f32_i32_e64 v143, v143
    v_pk_fma_f32 v[136:137], v[136:137], v[116:117], v[116:117] op_sel:[0,0,1] op_sel_hi:[1,0,1]
    v_pk_fma_f32 v[138:139], v[138:139], v[116:117], v[116:117] op_sel:[0,0,1] op_sel_hi:[1,0,1]
    v_pk_fma_f32 v[140:141], v[140:141], v[118:119], v[118:119] op_sel:[0,0,1] op_sel_hi:[1,0,1]
    v_pk_fma_f32 v[142:143], v[142:143], v[118:119], v[118:119] op_sel:[0,0,1] op_sel_hi:[1,0,1]
    ds_read_b128 v[116:119], v5 offset:80
    v_cvt_pk_bf16_f32 v49, v136, v140
    v_cvt_pk_bf16_f32 v53, v137, v141
    v_cvt_pk_bf16_f32 v57, v138, v142
    v_cvt_pk_bf16_f32 v61, v139, v143
    v_cvt_f32_i32 v144, v144
    v_cvt_f32_i32 v145, v145
    v_cvt_f32_i32 v148, v148
    v_cvt_f32_i32 v149, v149
    v_cvt_f32_i32 v152, v152
    s_waitcnt vmcnt(6)
    buffer_load_dwordx4 v[132:135], v1, s[8:11], s60 offen offset:1024 nt
    v_cvt_f32_i32 v153, v153
    v_cvt_f32_i32 v156, v156
    v_cvt_f32_i32_e64 v157, v157
    v_pk_fma_f32 v[144:145], v[144:145], v[120:121], v[120:121] op_sel:[0,0,1] op_sel_hi:[1,0,1]
    v_pk_fma_f32 v[148:149], v[148:149], v[122:123], v[122:123] op_sel:[0,0,1] op_sel_hi:[1,0,1]
    v_pk_fma_f32 v[152:153], v[152:153], v[124:125], v[124:125] op_sel:[0,0,1] op_sel_hi:[1,0,1]
    v_pk_fma_f32 v[156:157], v[156:157], v[126:127], v[126:127] op_sel:[0,0,1] op_sel_hi:[1,0,1]
    v_cvt_pk_bf16_f32 v50, v144, v148
    v_cvt_pk_bf16_f32 v51, v152, v156
    ds_write_b128 v6, v[48:51] offset:0
    v_cvt_f32_i32 v146, v146
    v_cvt_f32_i32 v147, v147
    v_cvt_f32_i32 v150, v150
    v_cvt_f32_i32 v151, v151
    v_cvt_f32_i32 v154, v154
    v_cvt_f32_i32 v155, v155
    v_cvt_f32_i32 v158, v158
    v_cvt_f32_i32_e64 v159, v159
    s_waitcnt vmcnt(6)
    buffer_load_dwordx4 v[136:139], v1, s[8:11], s60 offen offset:2048 nt
    v_cvt_pk_bf16_f32 v54, v145, v149
    v_cvt_pk_bf16_f32 v55, v153, v157
    ds_write_b128 v6, v[52:55] offset:576
    v_pk_fma_f32 v[146:147], v[146:147], v[120:121], v[120:121] op_sel:[0,0,1] op_sel_hi:[1,0,1]
    v_pk_fma_f32 v[150:151], v[150:151], v[122:123], v[122:123] op_sel:[0,0,1] op_sel_hi:[1,0,1]
    v_pk_fma_f32 v[154:155], v[154:155], v[124:125], v[124:125] op_sel:[0,0,1] op_sel_hi:[1,0,1]
    v_pk_fma_f32 v[158:159], v[158:159], v[126:127], v[126:127] op_sel:[0,0,1] op_sel_hi:[1,0,1]
    v_cvt_pk_bf16_f32 v58, v146, v150
    v_cvt_pk_bf16_f32 v59, v154, v158
    ds_write_b128 v6, v[56:59] offset:1152
    v_cvt_pk_bf16_f32 v62, v147, v151
    v_cvt_pk_bf16_f32 v63, v155, v159
    s_waitcnt vmcnt(6)
    buffer_load_dwordx4 v[140:143], v1, s[8:11], s60 offen offset:3072 nt
    ds_write_b128 v6, v[60:63] offset:1728
    ds_read_b128 v[120:123], v5 offset:96
    ds_read_b128 v[124:127], v5 offset:112
    v_xor_b32 v36, s53, v9
    ds_read_u16 v32, v36 offset:9728
    ds_read_u16 v33, v36 offset:13824
    s_branch L_restore
L_restf_:
    s_waitcnt vmcnt(6)
    buffer_load_dwordx4 v[144:147], v1, s[8:11], s61 offen offset:0 nt
    s_cmp_lg_u32 s49, 0
    s_cbranch_scc0 L_noatf
    s_mov_b64 exec, 1
    v_mov_b32 v38, s70
    buffer_atomic_add v38, off, s[28:31], s50 sc0
    s_mov_b64 exec, -1
L_noatf:
    s_waitcnt vmcnt(6)
    buffer_load_dwordx4 v[148:151], v1, s[8:11], s61 offen offset:1024 nt
    s_waitcnt lgkmcnt(0)
    s_barrier
    ds_read_b128 v[208:211], v7 offset:0
    ds_read_b128 v[212:215], v7 offset:16
    ds_read_b128 v[216:219], v7 offset:128
    ds_read_b128 v[220:223], v7 offset:144
    ds_read_b128 v[224:227], v7 offset:256
    ds_read_b128 v[228:231], v7 offset:272
    ds_read_b128 v[232:235], v7 offset:384
    ds_read_b128 v[236:239], v7 offset:400
    v_lshlrev_b32 v18, 16, v32
    v_lshlrev_b32 v19, 16, v33
    v_mul_f32 v19, -v19, v18
    s_waitcnt lgkmcnt(6)
    v_mfma_f32_16x16x32_bf16 v[64:67], v[208:211], v[96:99], v[64:67]
    ds_read_b128 v[240:243], v7 offset:9280
    v_mfma_f32_16x16x32_bf16 v[68:71], v[212:215], v[96:99], v[68:71]
    s_waitcnt vmcnt(6)
    buffer_load_dwordx4 v[152:155], v1, s[8:11], s61 offen offset:2048 nt
    ds_read_b128 v[244:247], v7 offset:9296
    s_waitcnt lgkmcnt(6)
    v_mfma_f32_16x16x32_bf16 v[72:75], v[216:219], v[96:99], v[72:75]
    ds_read_b128 v[208:211], v7 offset:9408
    v_mfma_f32_16x16x32_bf16 v[76:79], v[220:223], v[96:99], v[76:79]
    ds_read_b128 v[212:215], v7 offset:9424
    s_waitcnt lgkmcnt(6)
    v_mfma_f32_16x16x32_bf16 v[80:83], v[224:227], v[96:99], v[80:83]
    ds_read_b128 v[216:219], v7 offset:9536
    v_mfma_f32_16x16x32_bf16 v[84:87], v[228:231], v[96:99], v[84:87]
    ds_read_b128 v[220:223], v7 offset:9552
    s_waitcnt lgkmcnt(6)
    v_mfma_f32_16x16x32_bf16 v[88:91], v[232:235], v[96:99], v[88:91]
    ds_read_b128 v[224:227], v7 offset:9664
    v_mfma_f32_16x16x32_bf16 v[92:95], v[236:239], v[96:99], v[92:95]
    ds_read_b128 v[228:231], v7 offset:9680
    s_waitcnt lgkmcnt(6)
    s_waitcnt vmcnt(6)
    buffer_load_dwordx4 v[156:159], v1, s[8:11], s61 offen offset:3072 nt
    v_mfma_f32_16x16x32_bf16 v[64:67], v[240:243], v[100:103], v[64:67]
    v_mfma_f32_16x16x32_bf16 v[68:71], v[244:247], v[100:103], v[68:71]
    ds_write_b64 v4, v[18:19]
    s_waitcnt lgkmcnt(5)
    v_mfma_f32_16x16x32_bf16 v[72:75], v[208:211], v[100:103], v[72:75]
    v_mfma_f32_16x16x32_bf16 v[76:79], v[212:215], v[100:103], v[76:79]
    s_waitcnt lgkmcnt(3)
    v_mfma_f32_16x16x32_bf16 v[80:83], v[216:219], v[100:103], v[80:83]
    v_mfma_f32_16x16x32_bf16 v[84:87], v[220:223], v[100:103], v[84:87]
    s_waitcnt lgkmcnt(1)
    v_mfma_f32_16x16x32_bf16 v[88:91], v[224:227], v[100:103], v[88:91]
    v_mfma_f32_16x16x32_bf16 v[92:95], v[228:231], v[100:103], v[92:95]
    v_cvt_f32_i32 v160, v160
    v_cvt_f32_i32 v161, v161
    v_cvt_f32_i32 v162, v162
    v_cvt_f32_i32 v163, v163
    v_cvt_f32_i32 v164, v164
    v_cvt_f32_i32 v165, v165
    v_cvt_f32_i32 v166, v166
    v_cvt_f32_i32 v167, v167
    v_pk_fma_f32 v[160:161], v[160:161], v[112:113], v[112:113] op_sel:[0,0,1] op_sel_hi:[1,0,1]
    v_pk_fma_f32 v[162:163], v[162:163], v[112:113], v[112:113] op_sel:[0,0,1] op_sel_hi:[1,0,1]
    v_pk_fma_f32 v[164:165], v[164:165], v[114:115], v[114:115] op_sel:[0,0,1] op_sel_hi:[1,0,1]
    v_pk_fma_f32 v[166:167], v[166:167], v[114:115], v[114:115] op_sel:[0,0,1] op_sel_hi:[1,0,1]
    v_cvt_pk_bf16_f32 v48, v160, v164
    v_cvt_pk_bf16_f32 v52, v161, v165
    v_cvt_pk_bf16_f32 v56, v162, v166
    v_cvt_pk_bf16_f32 v60, v163, v167
    s_waitcnt vmcnt(6)
    buffer_load_dwordx4 v[160:163], v1, s[8:11], s62 offen offset:0 nt
    v_cvt_f32_i32 v168, v168
    v_cvt_f32_i32 v169, v169
    v_cvt_f32_i32 v170, v170
    v_cvt_f32_i32 v171, v171
    v_cvt_f32_i32 v172, v172
    v_cvt_f32_i32 v173, v173
    v_cvt_f32_i32_e64 v174, v174
    s_waitcnt vmcnt(6)
    buffer_load_dwordx4 v[164:167], v1, s[8:11], s62 offen offset:1024 nt
    v_cvt_f32_i32_e64 v175, v175
    v_pk_fma_f32 v[168:169], v[168:169], v[116:117], v[116:117] op_sel:[0,0,1] op_sel_hi:[1,0,1]
    v_pk_fma_f32 v[170:171], v[170:171], v[116:117], v[116:117] op_sel:[0,0,1] op_sel_hi:[1,0,1]
    v_pk_fma_f32 v[172:173], v[172:173], v[118:119], v[118:119] op_sel:[0,0,1] op_sel_hi:[1,0,1]
    v_pk_fma_f32 v[174:175], v[174:175], v[118:119], v[118:119] op_sel:[0,0,1] op_sel_hi:[1,0,1]
    v_cvt_pk_bf16_f32 v49, v168, v172
    v_cvt_pk_bf16_f32 v53, v169, v173
    v_cvt_pk_bf16_f32 v57, v170, v174
    v_cvt_pk_bf16_f32 v61, v171, v175
    v_cvt_f32_i32 v176, v176
    v_cvt_f32_i32 v177, v177
    v_cvt_f32_i32 v180, v180
    v_cvt_f32_i32 v181, v181
    v_cvt_f32_i32 v184, v184
    v_cvt_f32_i32 v185, v185
    v_cvt_f32_i32 v188, v188
    v_cvt_f32_i32 v189, v189
    v_pk_fma_f32 v[176:177], v[176:177], v[120:121], v[120:121] op_sel:[0,0,1] op_sel_hi:[1,0,1]
    v_pk_fma_f32 v[180:181], v[180:181], v[122:123], v[122:123] op_sel:[0,0,1] op_sel_hi:[1,0,1]
    v_pk_fma_f32 v[184:185], v[184:185], v[124:125], v[124:125] op_sel:[0,0,1] op_sel_hi:[1,0,1]
    v_pk_fma_f32 v[188:189], v[188:189], v[126:127], v[126:127] op_sel:[0,0,1] op_sel_hi:[1,0,1]
    v_cvt_pk_bf16_f32 v50, v176, v180
    v_cvt_pk_bf16_f32 v51, v184, v188
    ds_write_b128 v6, v[48:51] offset:18560
    s_waitcnt vmcnt(6)
    buffer_load_dwordx4 v[168:171], v1, s[8:11], s62 offen offset:2048 nt
    v_cvt_f32_i32 v178, v178
    v_cvt_f32_i32 v179, v179
    v_cvt_f32_i32 v182, v182
    v_cvt_f32_i32 v183, v183
    v_cvt_f32_i32 v186, v186
    v_cvt_f32_i32 v187, v187
    v_cvt_f32_i32 v190, v190
    v_cvt_f32_i32_e64 v191, v191
    v_cvt_pk_bf16_f32 v54, v177, v181
    v_cvt_pk_bf16_f32 v55, v185, v189
    ds_write_b128 v6, v[52:55] offset:19136
    v_pk_fma_f32 v[178:179], v[178:179], v[120:121], v[120:121] op_sel:[0,0,1] op_sel_hi:[1,0,1]
    s_waitcnt vmcnt(6)
    buffer_load_dwordx4 v[172:175], v1, s[8:11], s62 offen offset:3072 nt
    v_pk_fma_f32 v[182:183], v[182:183], v[122:123], v[122:123] op_sel:[0,0,1] op_sel_hi:[1,0,1]
    v_pk_fma_f32 v[186:187], v[186:187], v[124:125], v[124:125] op_sel:[0,0,1] op_sel_hi:[1,0,1]
    v_pk_fma_f32 v[190:191], v[190:191], v[126:127], v[126:127] op_sel:[0,0,1] op_sel_hi:[1,0,1]
    v_cvt_pk_bf16_f32 v58, v178, v182
    v_cvt_pk_bf16_f32 v59, v186, v190
    ds_write_b128 v6, v[56:59] offset:19712
    v_cvt_pk_bf16_f32 v62, v179, v183
    v_cvt_pk_bf16_f32 v63, v187, v191
    ds_write_b128 v6, v[60:63] offset:20288
    s_cmp_lg_u32 s49, 0
    s_cbranch_scc0 L_nopostf
    s_waitcnt vmcnt(7)
    ds_write_b32 v10, v38 offset:0
L_nopostf:
    s_waitcnt vmcnt(6)
    buffer_load_dwordx4 v[176:179], v1, s[8:11], s63 offen offset:0 nt
    s_waitcnt lgkmcnt(0)
    s_barrier
    ds_read_b128 v[208:211], v7 offset:18560
    s_waitcnt vmcnt(6)
    buffer_load_dwordx4 v[180:183], v1, s[8:11], s63 offen offset:1024 nt
    ds_read_b128 v[212:215], v7 offset:18576
    ds_read_b128 v[216:219], v7 offset:18688
    ds_read_b128 v[220:223], v7 offset:18704
    ds_read_b128 v[224:227], v7 offset:18816
    ds_read_b128 v[228:231], v7 offset:18832
    ds_read_b128 v[232:235], v7 offset:18944
    ds_read_b128 v[236:239], v7 offset:18960
    s_waitcnt lgkmcnt(6)
    v_mfma_f32_16x16x32_bf16 v[64:67], v[208:211], v[104:107], v[64:67]
    ds_read_b128 v[240:243], v7 offset:27840
    v_mfma_f32_16x16x32_bf16 v[68:71], v[212:215], v[104:107], v[68:71]
    ds_read_b128 v[244:247], v7 offset:27856
    s_waitcnt lgkmcnt(6)
    v_mfma_f32_16x16x32_bf16 v[72:75], v[216:219], v[104:107], v[72:75]
    ds_read_b128 v[208:211], v7 offset:27968
    v_mfma_f32_16x16x32_bf16 v[76:79], v[220:223], v[104:107], v[76:79]
    ds_read_b128 v[212:215], v7 offset:27984
    s_waitcnt lgkmcnt(6)
    v_mfma_f32_16x16x32_bf16 v[80:83], v[224:227], v[104:107], v[80:83]
    s_waitcnt vmcnt(6)
    buffer_load_dwordx4 v[184:187], v1, s[8:11], s63 offen offset:2048 nt
    ds_read_b128 v[216:219], v7 offset:28096
    v_mfma_f32_16x16x32_bf16 v[84:87], v[228:231], v[104:107], v[84:87]
    ds_read_b128 v[220:223], v7 offset:28112
    s_waitcnt lgkmcnt(6)
    v_mfma_f32_16x16x32_bf16 v[88:91], v[232:235], v[104:107], v[88:91]
    ds_read_b128 v[224:227], v7 offset:28224
    v_mfma_f32_16x16x32_bf16 v[92:95], v[236:239], v[104:107], v[92:95]
    ds_read_b128 v[228:231], v7 offset:28240
    s_waitcnt lgkmcnt(6)
    v_mfma_f32_16x16x32_bf16 v[64:67], v[240:243], v[108:111], v[64:67]
    ds_read_b128 v[112:115], v5 offset:0
    v_mfma_f32_16x16x32_bf16 v[68:71], v[244:247], v[108:111], v[68:71]
    ds_read_b128 v[116:119], v5 offset:16
    s_waitcnt lgkmcnt(6)
    v_mfma_f32_16x16x32_bf16 v[72:75], v[208:211], v[108:111], v[72:75]
    ds_read_b128 v[120:123], v5 offset:32
    v_mfma_f32_16x16x32_bf16 v[76:79], v[212:215], v[108:111], v[76:79]
    s_waitcnt vmcnt(6)
    buffer_load_dwordx4 v[188:191], v1, s[8:11], s63 offen offset:3072 nt
    ds_read_b128 v[124:127], v5 offset:48
    s_waitcnt lgkmcnt(6)
    v_mfma_f32_16x16x32_bf16 v[80:83], v[216:219], v[108:111], v[80:83]
    ds_read_b32 v34, v2
    v_mfma_f32_16x16x32_bf16 v[84:87], v[220:223], v[108:111], v[84:87]
    s_waitcnt lgkmcnt(5)
    v_mfma_f32_16x16x32_bf16 v[88:91], v[224:227], v[108:111], v[88:91]
    v_mfma_f32_16x16x32_bf16 v[92:95], v[228:231], v[108:111], v[92:95]
    s_branch L_V
L_Vs_:
    v_cvt_f32_i32 v128, v128
    v_cvt_f32_i32 v129, v129
    v_cvt_f32_i32 v130, v130
    v_cvt_f32_i32 v131, v131
    v_cvt_f32_i32 v132, v132
    v_cvt_f32_i32 v133, v133
    v_cvt_f32_i32 v134, v134
    v_cvt_f32_i32_e64 v135, v135
    v_pk_fma_f32 v[128:129], v[128:129], v[112:113], v[112:113] op_sel:[0,0,1] op_sel_hi:[1,0,1]
    v_pk_fma_f32 v[130:131], v[130:131], v[112:113], v[112:113] op_sel:[0,0,1] op_sel_hi:[1,0,1]
    v_pk_fma_f32 v[132:133], v[132:133], v[114:115], v[114:115] op_sel:[0,0,1] op_sel_hi:[1,0,1]
    v_pk_fma_f32 v[134:135], v[134:135], v[114:115], v[114:115] op_sel:[0,0,1] op_sel_hi:[1,0,1]
    ds_read_b128 v[112:115], v5 offset:64
    v_cvt_pk_bf16_f32 v48, v128, v132
    v_cvt_pk_bf16_f32 v52, v129, v133
    v_cvt_pk_bf16_f32 v56, v130, v134
    v_cvt_pk_bf16_f32 v60, v131, v135
    s_waitcnt vmcnt(3)
    buffer_load_dwordx4 v[128:131], v1, s[8:11], s60 offen offset:0 nt
    v_cvt_f32_i32 v136, v136
    v_cvt_f32_i32 v137, v137
    v_cvt_f32_i32 v138, v138
    v_cvt_f32_i32 v139, v139
    v_cvt_f32_i32 v140, v140
    v_cvt_f32_i32 v141, v141
    v_cvt_f32_i32 v142, v142
    v_cvt_f32_i32_e64 v143, v143
    v_pk_fma_f32 v[136:137], v[136:137], v[116:117], v[116:117] op_sel:[0,0,1] op_sel_hi:[1,0,1]
    v_pk_fma_f32 v[138:139], v[138:139], v[116:117], v[116:117] op_sel:[0,0,1] op_sel_hi:[1,0,1]
    v_pk_fma_f32 v[140:141], v[140:141], v[118:119], v[118:119] op_sel:[0,0,1] op_sel_hi:[1,0,1]
    v_pk_fma_f32 v[142:143], v[142:143], v[118:119], v[118:119] op_sel:[0,0,1] op_sel_hi:[1,0,1]
    ds_read_b128 v[116:119], v5 offset:80
    v_cvt_pk_bf16_f32 v49, v136, v140
    v_cvt_pk_bf16_f32 v53, v137, v141
    v_cvt_pk_bf16_f32 v57, v138, v142
    v_cvt_pk_bf16_f32 v61, v139, v143
    v_cvt_f32_i32 v144, v144
    v_cvt_f32_i32 v145, v145
    v_cvt_f32_i32 v148, v148
    v_cvt_f32_i32 v149, v149
    v_cvt_f32_i32_e64 v152, v152
    buffer_load_dwordx4 v[132:135], v1, s[8:11], s60 offen offset:1024 nt
    v_cvt_f32_i32 v153, v153
    v_cvt_f32_i32 v156, v156
    v_cvt_f32_i32_e64 v157, v157
    v_pk_fma_f32 v[144:145], v[144:145], v[120:121], v[120:121] op_sel:[0,0,1] op_sel_hi:[1,0,1]
    v_pk_fma_f32 v[148:149], v[148:149], v[122:123], v[122:123] op_sel:[0,0,1] op_sel_hi:[1,0,1]
    v_pk_fma_f32 v[152:153], v[152:153], v[124:125], v[124:125] op_sel:[0,0,1] op_sel_hi:[1,0,1]
    v_pk_fma_f32 v[156:157], v[156:157], v[126:127], v[126:127] op_sel:[0,0,1] op_sel_hi:[1,0,1]
    v_cvt_pk_bf16_f32 v50, v144, v148
    v_cvt_pk_bf16_f32 v51, v152, v156
    ds_write_b128 v6, v[48:51] offset:0
    v_cvt_f32_i32 v146, v146
    v_cvt_f32_i32 v147, v147
    v_cvt_f32_i32 v150, v150
    v_cvt_f32_i32 v151, v151
    v_cvt_f32_i32 v154, v154
    v_cvt_f32_i32 v155, v155
    v_cvt_f32_i32 v158, v158
    v_cvt_f32_i32_e64 v159, v159
    s_waitcnt vmcnt(3)
    buffer_load_dwordx4 v[136:139], v1, s[8:11], s60 offen offset:2048 nt
    v_cvt_pk_bf16_f32 v54, v145, v149
    v_cvt_pk_bf16_f32 v55, v153, v157
    ds_write_b128 v6, v[52:55] offset:576
    v_pk_fma_f32 v[146:147], v[146:147], v[120:121], v[120:121] op_sel:[0,0,1] op_sel_hi:[1,0,1]
    v_pk_fma_f32 v[150:151], v[150:151], v[122:123], v[122:123] op_sel:[0,0,1] op_sel_hi:[1,0,1]
    v_pk_fma_f32 v[154:155], v[154:155], v[124:125], v[124:125] op_sel:[0,0,1] op_sel_hi:[1,0,1]
    v_pk_fma_f32 v[158:159], v[158:159], v[126:127], v[126:127] op_sel:[0,0,1] op_sel_hi:[1,0,1]
    v_cvt_pk_bf16_f32 v58, v146, v150
    v_cvt_pk_bf16_f32 v59, v154, v158
    ds_write_b128 v6, v[56:59] offset:1152
    v_cvt_pk_bf16_f32 v62, v147, v151
    v_cvt_pk_bf16_f32 v63, v155, v159
    buffer_load_dwordx4 v[140:143], v1, s[8:11], s60 offen offset:3072 nt
    ds_write_b128 v6, v[60:63] offset:1728
    ds_read_b128 v[120:123], v5 offset:96
    ds_read_b128 v[124:127], v5 offset:112
    v_xor_b32_e64 v36, s53, v9
    ds_read_u16 v32, v36 offset:9728
    ds_read_u16 v33, v36 offset:13824
    s_branch L_restore
L_rests_:
    s_waitcnt vmcnt(3)
    buffer_load_dwordx4 v[144:147], v1, s[8:11], s61 offen offset:0 nt
    s_cmp_lg_u32 s49, 0
    s_cbranch_scc0 L_noats
    s_mov_b64 exec, 1
    v_mov_b32 v38, s70
    buffer_atomic_add v38, off, s[28:31], s50 sc0
    s_mov_b64 exec, -1
L_noats:
    buffer_load_dwordx4 v[148:151], v1, s[8:11], s61 offen offset:1024 nt
    s_waitcnt lgkmcnt(0)
    s_barrier
    ds_read_b128 v[208:211], v7 offset:0
    ds_read_b128 v[212:215], v7 offset:16
    ds_read_b128 v[216:219], v7 offset:128
    ds_read_b128 v[220:223], v7 offset:144
    ds_read_b128 v[224:227], v7 offset:256
    ds_read_b128 v[228:231], v7 offset:272
    ds_read_b128 v[232:235], v7 offset:384
    ds_read_b128 v[236:239], v7 offset:400
    v_lshlrev_b32 v18, 16, v32
    v_lshlrev_b32_e64 v19, 16, v33
    v_mul_f32 v19, -v19, v18
    s_waitcnt lgkmcnt(6)
    v_mfma_f32_16x16x32_bf16 v[64:67], v[208:211], v[96:99], v[64:67]
    ds_read_b128 v[240:243], v7 offset:9280
    v_mfma_f32_16x16x32_bf16 v[68:71], v[212:215], v[96:99], v[68:71]
    s_waitcnt vmcnt(3)
    buffer_load_dwordx4 v[152:155], v1, s[8:11], s61 offen offset:2048 nt
    ds_read_b128 v[244:247], v7 offset:9296
    s_waitcnt lgkmcnt(6)
    v_mfma_f32_16x16x32_bf16 v[72:75], v[216:219], v[96:99], v[72:75]
    ds_read_b128 v[208:211], v7 offset:9408
    v_mfma_f32_16x16x32_bf16 v[76:79], v[220:223], v[96:99], v[76:79]
    ds_read_b128 v[212:215], v7 offset:9424
    s_waitcnt lgkmcnt(6)
    v_mfma_f32_16x16x32_bf16 v[80:83], v[224:227], v[96:99], v[80:83]
    ds_read_b128 v[216:219], v7 offset:9536
    v_mfma_f32_16x16x32_bf16 v[84:87], v[228:231], v[96:99], v[84:87]
    ds_read_b128 v[220:223], v7 offset:9552
    s_waitcnt lgkmcnt(6)
    v_mfma_f32_16x16x32_bf16 v[88:91], v[232:235], v[96:99], v[88:91]
    ds_read_b128 v[224:227], v7 offset:9664
    v_mfma_f32_16x16x32_bf16 v[92:95], v[236:239], v[96:99], v[92:95]
    ds_read_b128 v[228:231], v7 offset:9680
    s_waitcnt lgkmcnt(6)
    buffer_load_dwordx4 v[156:159], v1, s[8:11], s61 offen offset:3072 nt
    v_mfma_f32_16x16x32_bf16 v[64:67], v[240:243], v[100:103], v[64:67]
    v_mfma_f32_16x16x32_bf16 v[68:71], v[244:247], v[100:103], v[68:71]
    ds_write_b64 v4, v[18:19]
    s_waitcnt lgkmcnt(5)
    v_mfma_f32_16x16x32_bf16 v[72:75], v[208:211], v[100:103], v[72:75]
    v_mfma_f32_16x16x32_bf16 v[76:79], v[212:215], v[100:103], v[76:79]
    s_waitcnt lgkmcnt(3)
    v_mfma_f32_16x16x32_bf16 v[80:83], v[216:219], v[100:103], v[80:83]
    v_mfma_f32_16x16x32_bf16 v[84:87], v[220:223], v[100:103], v[84:87]
    s_waitcnt lgkmcnt(1)
    v_mfma_f32_16x16x32_bf16 v[88:91], v[224:227], v[100:103], v[88:91]
    v_mfma_f32_16x16x32_bf16 v[92:95], v[228:231], v[100:103], v[92:95]
    v_cvt_f32_i32 v160, v160
    v_cvt_f32_i32 v161, v161
    v_cvt_f32_i32 v162, v162
    v_cvt_f32_i32 v163, v163
    v_cvt_f32_i32 v164, v164
    v_cvt_f32_i32 v165, v165
    v_cvt_f32_i32 v166, v166
    v_cvt_f32_i32_e64 v167, v167
    v_pk_fma_f32 v[160:161], v[160:161], v[112:113], v[112:113] op_sel:[0,0,1] op_sel_hi:[1,0,1]
    v_pk_fma_f32 v[162:163], v[162:163], v[112:113], v[112:113] op_sel:[0,0,1] op_sel_hi:[1,0,1]
    v_pk_fma_f32 v[164:165], v[164:165], v[114:115], v[114:115] op_sel:[0,0,1] op_sel_hi:[1,0,1]
    v_pk_fma_f32 v[166:167], v[166:167], v[114:115], v[114:115] op_sel:[0,0,1] op_sel_hi:[1,0,1]
    v_cvt_pk_bf16_f32 v48, v160, v164
    v_cvt_pk_bf16_f32 v52, v161, v165
    v_cvt_pk_bf16_f32 v56, v162, v166
    v_cvt_pk_bf16_f32 v60, v163, v167
    s_waitcnt vmcnt(3)
    buffer_load_dwordx4 v[160:163], v1, s[8:11], s62 offen offset:0 nt
    v_cvt_f32_i32 v168, v168
    v_cvt_f32_i32 v169, v169
    v_cvt_f32_i32 v170, v170
    v_cvt_f32_i32 v171, v171
    v_cvt_f32_i32 v172, v172
    v_cvt_f32_i32 v173, v173
    v_cvt_f32_i32 v174, v174
    buffer_load_dwordx4 v[164:167], v1, s[8:11], s62 offen offset:1024 nt
    v_cvt_f32_i32_e64 v175, v175
    v_pk_fma_f32 v[168:169], v[168:169], v[116:117], v[116:117] op_sel:[0,0,1] op_sel_hi:[1,0,1]
    v_pk_fma_f32 v[170:171], v[170:171], v[116:117], v[116:117] op_sel:[0,0,1] op_sel_hi:[1,0,1]
    v_pk_fma_f32 v[172:173], v[172:173], v[118:119], v[118:119] op_sel:[0,0,1] op_sel_hi:[1,0,1]
    v_pk_fma_f32 v[174:175], v[174:175], v[118:119], v[118:119] op_sel:[0,0,1] op_sel_hi:[1,0,1]
    v_cvt_pk_bf16_f32 v49, v168, v172
    v_cvt_pk_bf16_f32 v53, v169, v173
    v_cvt_pk_bf16_f32 v57, v170, v174
    v_cvt_pk_bf16_f32 v61, v171, v175
    v_cvt_f32_i32 v176, v176
    v_cvt_f32_i32 v177, v177
    v_cvt_f32_i32 v180, v180
    v_cvt_f32_i32 v181, v181
    v_cvt_f32_i32 v184, v184
    v_cvt_f32_i32 v185, v185
    v_cvt_f32_i32 v188, v188
    v_cvt_f32_i32 v189, v189
    v_pk_fma_f32 v[176:177], v[176:177], v[120:121], v[120:121] op_sel:[0,0,1] op_sel_hi:[1,0,1]
    v_pk_fma_f32 v[180:181], v[180:181], v[122:123], v[122:123] op_sel:[0,0,1] op_sel_hi:[1,0,1]
    v_pk_fma_f32 v[184:185], v[184:185], v[124:125], v[124:125] op_sel:[0,0,1] op_sel_hi:[1,0,1]
    v_pk_fma_f32 v[188:189], v[188:189], v[126:127], v[126:127] op_sel:[0,0,1] op_sel_hi:[1,0,1]
    v_cvt_pk_bf16_f32 v50, v176, v180
    v_cvt_pk_bf16_f32 v51, v184, v188
    ds_write_b128 v6, v[48:51] offset:18560
    s_waitcnt vmcnt(3)
    buffer_load_dwordx4 v[168:171], v1, s[8:11], s62 offen offset:2048 nt
    v_cvt_f32_i32 v178, v178
    v_cvt_f32_i32 v179, v179
    v_cvt_f32_i32 v182, v182
    v_cvt_f32_i32 v183, v183
    v_cvt_f32_i32 v186, v186
    v_cvt_f32_i32 v187, v187
    v_cvt_f32_i32 v190, v190
    v_cvt_f32_i32_e64 v191, v191
    v_cvt_pk_bf16_f32 v54, v177, v181
    v_cvt_pk_bf16_f32 v55, v185, v189
    ds_write_b128 v6, v[52:55] offset:19136
    v_pk_fma_f32 v[178:179], v[178:179], v[120:121], v[120:121] op_sel:[0,0,1] op_sel_hi:[1,0,1]
    buffer_load_dwordx4 v[172:175], v1, s[8:11], s62 offen offset:3072 nt
    v_pk_fma_f32 v[182:183], v[182:183], v[122:123], v[122:123] op_sel:[0,0,1] op_sel_hi:[1,0,1]
    v_pk_fma_f32 v[186:187], v[186:187], v[124:125], v[124:125] op_sel:[0,0,1] op_sel_hi:[1,0,1]
    v_pk_fma_f32 v[190:191], v[190:191], v[126:127], v[126:127] op_sel:[0,0,1] op_sel_hi:[1,0,1]
    v_cvt_pk_bf16_f32 v58, v178, v182
    v_cvt_pk_bf16_f32 v59, v186, v190
    ds_write_b128 v6, v[56:59] offset:19712
    v_cvt_pk_bf16_f32 v62, v179, v183
    v_cvt_pk_bf16_f32 v63, v187, v191
    ds_write_b128 v6, v[60:63] offset:20288
    s_cmp_lg_u32 s49, 0
    s_cbranch_scc0 L_noposts
    s_waitcnt vmcnt(7)
    ds_write_b32 v10, v38 offset:0
L_noposts:
    s_waitcnt vmcnt(3)
    buffer_load_dwordx4 v[176:179], v1, s[8:11], s63 offen offset:0 nt
    s_waitcnt lgkmcnt(0)
    s_barrier
    ds_read_b128 v[208:211], v7 offset:18560
    buffer_load_dwordx4 v[180:183], v1, s[8:11], s63 offen offset:1024 nt
    ds_read_b128 v[212:215], v7 offset:18576
    ds_read_b128 v[216:219], v7 offset:18688
    ds_read_b128 v[220:223], v7 offset:18704
    ds_read_b128 v[224:227], v7 offset:18816
    ds_read_b128 v[228:231], v7 offset:18832
    ds_read_b128 v[232:235], v7 offset:18944
    ds_read_b128 v[236:239], v7 offset:18960
    s_waitcnt lgkmcnt(6)
    v_mfma_f32_16x16x32_bf16 v[64:67], v[208:211], v[104:107], v[64:67]
    ds_read_b128 v[240:243], v7 offset:27840
    v_mfma_f32_16x16x32_bf16 v[68:71], v[212:215], v[104:107], v[68:71]
    ds_read_b128 v[244:247], v7 offset:27856
    s_waitcnt lgkmcnt(6)
    v_mfma_f32_16x16x32_bf16 v[72:75], v[216:219], v[104:107], v[72:75]
    ds_read_b128 v[208:211], v7 offset:27968
    v_mfma_f32_16x16x32_bf16 v[76:79], v[220:223], v[104:107], v[76:79]
    ds_read_b128 v[212:215], v7 offset:27984
    s_waitcnt lgkmcnt(6)
    v_mfma_f32_16x16x32_bf16 v[80:83], v[224:227], v[104:107], v[80:83]
    s_waitcnt vmcnt(3)
    buffer_load_dwordx4 v[184:187], v1, s[8:11], s63 offen offset:2048 nt
    ds_read_b128 v[216:219], v7 offset:28096
    v_mfma_f32_16x16x32_bf16 v[84:87], v[228:231], v[104:107], v[84:87]
    ds_read_b128 v[220:223], v7 offset:28112
    s_waitcnt lgkmcnt(6)
    v_mfma_f32_16x16x32_bf16 v[88:91], v[232:235], v[104:107], v[88:91]
    ds_read_b128 v[224:227], v7 offset:28224
    v_mfma_f32_16x16x32_bf16 v[92:95], v[236:239], v[104:107], v[92:95]
    ds_read_b128 v[228:231], v7 offset:28240
    s_waitcnt lgkmcnt(6)
    v_mfma_f32_16x16x32_bf16 v[64:67], v[240:243], v[108:111], v[64:67]
    ds_read_b128 v[112:115], v5 offset:0
    v_mfma_f32_16x16x32_bf16 v[68:71], v[244:247], v[108:111], v[68:71]
    ds_read_b128 v[116:119], v5 offset:16
    s_waitcnt lgkmcnt(6)
    v_mfma_f32_16x16x32_bf16 v[72:75], v[208:211], v[108:111], v[72:75]
    ds_read_b128 v[120:123], v5 offset:32
    v_mfma_f32_16x16x32_bf16 v[76:79], v[212:215], v[108:111], v[76:79]
    buffer_load_dwordx4 v[188:191], v1, s[8:11], s63 offen offset:3072 nt
    ds_read_b128 v[124:127], v5 offset:48
    s_waitcnt lgkmcnt(6)
    v_mfma_f32_16x16x32_bf16 v[80:83], v[216:219], v[108:111], v[80:83]
    ds_read_b32 v34, v2
    v_mfma_f32_16x16x32_bf16 v[84:87], v[220:223], v[108:111], v[84:87]
    s_waitcnt lgkmcnt(5)
    v_mfma_f32_16x16x32_bf16 v[88:91], v[224:227], v[108:111], v[88:91]
    v_mfma_f32_16x16x32_bf16 v[92:95], v[228:231], v[108:111], v[92:95]
    s_branch L_V
L_last:
    s_lshr_b32 s55, s44, s71
    s_and_b32 s55, s55, 7
    s_lshl2_add_u32 s44, s40, s3
    s_lshl_b32 s44, s44, 15
    s_add_u32 s44, s44, 1048576
    v_lshrrev_b32 v20, 4, v0
    v_and_b32 v21, 15, v0
    v_xor_b32 v20, s41, v20
    v_lshlrev_b32 v20, 13, v20
    v_lshl_add_u32 v20, v21, 3, v20
    v_add_u32 v20, 4096, v20
    v_lshlrev_b32 v21, 2, v21
    s_xor_b32 s45, s41, 0
    s_lshl_b32 s45, s45, 13
    s_add_u32 s75, s44, s45
    s_xor_b32 s45, s41, 1
    s_lshl_b32 s45, s45, 13
    s_add_u32 s76, s44, s45
    s_xor_b32 s45, s41, 2
    s_lshl_b32 s45, s45, 13
    s_add_u32 s77, s44, s45
    s_xor_b32 s45, s41, 3
    s_lshl_b32 s45, s45, 13
    s_add_u32 s78, s44, s45
    s_cmp_eq_u32 s55, 3
    s_mov_b32 s55, 14
    v_cvt_f32_i32 v128, v128
    v_cvt_f32_i32 v129, v129
    v_cvt_f32_i32 v130, v130
    v_cvt_f32_i32 v131, v131
    v_cvt_f32_i32 v132, v132
    v_cvt_f32_i32 v133, v133
    v_cvt_f32_i32 v134, v134
    v_cvt_f32_i32_e64 v135, v135
    v_pk_fma_f32 v[128:129], v[128:129], v[112:113], v[112:113] op_sel:[0,0,1] op_sel_hi:[1,0,1]
    v_pk_fma_f32 v[130:131], v[130:131], v[112:113], v[112:113] op_sel:[0,0,1] op_sel_hi:[1,0,1]
    v_pk_fma_f32 v[132:133], v[132:133], v[114:115], v[114:115] op_sel:[0,0,1] op_sel_hi:[1,0,1]
    v_pk_fma_f32 v[134:135], v[134:135], v[114:115], v[114:115] op_sel:[0,0,1] op_sel_hi:[1,0,1]
    ds_read_b128 v[112:115], v5 offset:64
    v_cvt_pk_bf16_f32 v48, v128, v132
    v_cvt_pk_bf16_f32 v52, v129, v133
    v_cvt_pk_bf16_f32 v56, v130, v134
    v_cvt_pk_bf16_f32 v60, v131, v135
    v_cvt_f32_i32 v136, v136
    v_cvt_f32_i32 v137, v137
    v_cvt_f32_i32 v138, v138
    v_cvt_f32_i32 v139, v139
    v_cvt_f32_i32 v140, v140
    v_cvt_f32_i32 v141, v141
    v_cvt_f32_i32 v142, v142
    v_cvt_f32_i32 v143, v143
    v_pk_fma_f32 v[136:137], v[136:137], v[116:117], v[116:117] op_sel:[0,0,1] op_sel_hi:[1,0,1]
    v_pk_fma_f32 v[138:139], v[138:139], v[116:117], v[116:117] op_sel:[0,0,1] op_sel_hi:[1,0,1]
    v_pk_fma_f32 v[140:141], v[140:141], v[118:119], v[118:119] op_sel:[0,0,1] op_sel_hi:[1,0,1]
    v_pk_fma_f32 v[142:143], v[142:143], v[118:119], v[118:119] op_sel:[0,0,1] op_sel_hi:[1,0,1]
    ds_read_b128 v[116:119], v5 offset:80
    v_cvt_pk_bf16_f32 v49, v136, v140
    v_cvt_pk_bf16_f32 v53, v137, v141
    v_cvt_pk_bf16_f32 v57, v138, v142
    v_cvt_pk_bf16_f32 v61, v139, v143
    v_cvt_f32_i32 v144, v144
    v_cvt_f32_i32 v145, v145
    v_cvt_f32_i32 v148, v148
    v_cvt_f32_i32 v149, v149
    v_cvt_f32_i32 v152, v152
    v_cvt_f32_i32 v153, v153
    v_cvt_f32_i32 v156, v156
    v_cvt_f32_i32 v157, v157
    v_pk_fma_f32 v[144:145], v[144:145], v[120:121], v[120:121] op_sel:[0,0,1] op_sel_hi:[1,0,1]
    v_pk_fma_f32 v[148:149], v[148:149], v[122:123], v[122:123] op_sel:[0,0,1] op_sel_hi:[1,0,1]
    v_pk_fma_f32 v[152:153], v[152:153], v[124:125], v[124:125] op_sel:[0,0,1] op_sel_hi:[1,0,1]
    v_pk_fma_f32 v[156:157], v[156:157], v[126:127], v[126:127] op_sel:[0,0,1] op_sel_hi:[1,0,1]
    v_cvt_pk_bf16_f32 v50, v144, v148
    v_cvt_pk_bf16_f32 v51, v152, v156
    ds_write_b128 v6, v[48:51] offset:0
    v_cvt_f32_i32 v146, v146
    v_cvt_f32_i32 v147, v147
    v_cvt_f32_i32 v150, v150
    v_cvt_f32_i32 v151, v151
    v_cvt_f32_i32 v154, v154
    v_cvt_f32_i32 v155, v155
    v_cvt_f32_i32 v158, v158
    v_cvt_f32_i32 v159, v159
    v_cvt_pk_bf16_f32 v54, v145, v149
    v_cvt_pk_bf16_f32 v55, v153, v157
    ds_write_b128 v6, v[52:55] offset:576
    v_pk_fma_f32 v[146:147], v[146:147], v[120:121], v[120:121] op_sel:[0,0,1] op_sel_hi:[1,0,1]
    v_pk_fma_f32 v[150:151], v[150:151], v[122:123], v[122:123] op_sel:[0,0,1] op_sel_hi:[1,0,1]
    v_pk_fma_f32 v[154:155], v[154:155], v[124:125], v[124:125] op_sel:[0,0,1] op_sel_hi:[1,0,1]
    v_pk_fma_f32 v[158:159], v[158:159], v[126:127], v[126:127] op_sel:[0,0,1] op_sel_hi:[1,0,1]
    v_cvt_pk_bf16_f32 v58, v146, v150
    v_cvt_pk_bf16_f32 v59, v154, v158
    ds_write_b128 v6, v[56:59] offset:1152
    v_cvt_pk_bf16_f32 v62, v147, v151
    v_cvt_pk_bf16_f32 v63, v155, v159
    ds_write_b128 v6, v[60:63] offset:1728
    ds_read_b128 v[120:123], v5 offset:96
    ds_read_b128 v[124:127], v5 offset:112
    v_cmp_neq_f32 vcc, v248, v39
    s_cbranch_vccnz L_oldrefE
L_newrefE:
    s_waitcnt lgkmcnt(0)
    s_barrier
    ds_read_b128 v[208:211], v7 offset:0
    ds_read_b128 v[212:215], v7 offset:16
    ds_read_b128 v[216:219], v7 offset:128
    ds_read_b128 v[220:223], v7 offset:144
    ds_read_b128 v[224:227], v7 offset:256
    ds_read_b128 v[228:231], v7 offset:272
    ds_read_b128 v[232:235], v7 offset:384
    ds_read_b128 v[236:239], v7 offset:400
    s_waitcnt lgkmcnt(6)
    v_mfma_f32_16x16x32_bf16 v[64:67], v[208:211], v[192:195], v[64:67]
    ds_read_b128 v[240:243], v7 offset:9280
    v_mfma_f32_16x16x32_bf16 v[68:71], v[212:215], v[192:195], v[68:71]
    ds_read_b128 v[244:247], v7 offset:9296
    s_waitcnt lgkmcnt(6)
    v_mfma_f32_16x16x32_bf16 v[72:75], v[216:219], v[192:195], v[72:75]
    ds_read_b128 v[208:211], v7 offset:9408
    v_mfma_f32_16x16x32_bf16 v[76:79], v[220:223], v[192:195], v[76:79]
    ds_read_b128 v[212:215], v7 offset:9424
    s_waitcnt lgkmcnt(6)
    v_mfma_f32_16x16x32_bf16 v[80:83], v[224:227], v[192:195], v[80:83]
    ds_read_b128 v[216:219], v7 offset:9536
    v_mfma_f32_16x16x32_bf16 v[84:87], v[228:231], v[192:195], v[84:87]
    ds_read_b128 v[220:223], v7 offset:9552
    s_waitcnt lgkmcnt(6)
    v_mfma_f32_16x16x32_bf16 v[88:91], v[232:235], v[192:195], v[88:91]
    ds_read_b128 v[224:227], v7 offset:9664
    v_mfma_f32_16x16x32_bf16 v[92:95], v[236:239], v[192:195], v[92:95]
    ds_read_b128 v[228:231], v7 offset:9680
    s_waitcnt lgkmcnt(6)
    v_mfma_f32_16x16x32_bf16 v[64:67], v[240:243], v[196:199], v[64:67]
    v_mfma_f32_16x16x32_bf16 v[68:71], v[244:247], v[196:199], v[68:71]
    s_waitcnt lgkmcnt(4)
    v_mfma_f32_16x16x32_bf16 v[72:75], v[208:211], v[196:199], v[72:75]
    v_mfma_f32_16x16x32_bf16 v[76:79], v[212:215], v[196:199], v[76:79]
    s_waitcnt lgkmcnt(2)
    v_mfma_f32_16x16x32_bf16 v[80:83], v[216:219], v[196:199], v[80:83]
    v_mfma_f32_16x16x32_bf16 v[84:87], v[220:223], v[196:199], v[84:87]
    s_waitcnt lgkmcnt(0)
    v_mfma_f32_16x16x32_bf16 v[88:91], v[224:227], v[196:199], v[88:91]
    v_mfma_f32_16x16x32_bf16 v[92:95], v[228:231], v[196:199], v[92:95]
    s_waitcnt vmcnt(6)
    v_cvt_f32_i32 v160, v160
    v_cvt_f32_i32 v161, v161
    v_cvt_f32_i32 v162, v162
    v_cvt_f32_i32 v163, v163
    v_cvt_f32_i32 v164, v164
    v_cvt_f32_i32 v165, v165
    v_cvt_f32_i32 v166, v166
    v_cvt_f32_i32_e64 v167, v167
    v_pk_fma_f32 v[160:161], v[160:161], v[112:113], v[112:113] op_sel:[0,0,1] op_sel_hi:[1,0,1]
    v_pk_fma_f32 v[162:163], v[162:163], v[112:113], v[112:113] op_sel:[0,0,1] op_sel_hi:[1,0,1]
    v_pk_fma_f32 v[164:165], v[164:165], v[114:115], v[114:115] op_sel:[0,0,1] op_sel_hi:[1,0,1]
    v_pk_fma_f32 v[166:167], v[166:167], v[114:115], v[114:115] op_sel:[0,0,1] op_sel_hi:[1,0,1]
    v_cvt_pk_bf16_f32 v48, v160, v164
    v_cvt_pk_bf16_f32 v52, v161, v165
    v_cvt_pk_bf16_f32 v56, v162, v166
    v_cvt_pk_bf16_f32 v60, v163, v167
    s_waitcnt vmcnt(4)
    v_cvt_f32_i32 v168, v168
    v_cvt_f32_i32 v169, v169
    v_cvt_f32_i32 v170, v170
    v_cvt_f32_i32 v171, v171
    v_cvt_f32_i32 v172, v172
    v_cvt_f32_i32 v173, v173
    v_cvt_f32_i32 v174, v174
    v_cvt_f32_i32_e64 v175, v175
    v_pk_fma_f32 v[168:169], v[168:169], v[116:117], v[116:117] op_sel:[0,0,1] op_sel_hi:[1,0,1]
    v_pk_fma_f32 v[170:171], v[170:171], v[116:117], v[116:117] op_sel:[0,0,1] op_sel_hi:[1,0,1]
    v_pk_fma_f32 v[172:173], v[172:173], v[118:119], v[118:119] op_sel:[0,0,1] op_sel_hi:[1,0,1]
    v_pk_fma_f32 v[174:175], v[174:175], v[118:119], v[118:119] op_sel:[0,0,1] op_sel_hi:[1,0,1]
    v_cvt_pk_bf16_f32 v49, v168, v172
    v_cvt_pk_bf16_f32 v53, v169, v173
    v_cvt_pk_bf16_f32 v57, v170, v174
    v_cvt_pk_bf16_f32 v61, v171, v175
    s_waitcnt vmcnt(2)
    v_cvt_f32_i32 v176, v176
    v_cvt_f32_i32 v177, v177
    v_cvt_f32_i32 v178, v178
    v_cvt_f32_i32 v179, v179
    v_cvt_f32_i32 v180, v180
    v_cvt_f32_i32 v181, v181
    v_cvt_f32_i32 v182, v182
    v_cvt_f32_i32_e64 v183, v183
    v_pk_fma_f32 v[176:177], v[176:177], v[120:121], v[120:121] op_sel:[0,0,1] op_sel_hi:[1,0,1]
    v_pk_fma_f32 v[178:179], v[178:179], v[120:121], v[120:121] op_sel:[0,0,1] op_sel_hi:[1,0,1]
    v_pk_fma_f32 v[180:181], v[180:181], v[122:123], v[122:123] op_sel:[0,0,1] op_sel_hi:[1,0,1]
    v_pk_fma_f32 v[182:183], v[182:183], v[122:123], v[122:123] op_sel:[0,0,1] op_sel_hi:[1,0,1]
    v_cvt_pk_bf16_f32 v50, v176, v180
    v_cvt_pk_bf16_f32 v54, v177, v181
    v_cvt_pk_bf16_f32 v58, v178, v182
    v_cvt_pk_bf16_f32 v62, v179, v183
    s_waitcnt vmcnt(0)
    s_cbranch_scc0 L_nolook
    buffer_load_dwordx2 v[24:25], v20, s[28:31], s44 offen sc0 sc1
L_nolook:
    v_cvt_f32_i32 v184, v184
    v_cvt_f32_i32 v185, v185
    v_cvt_f32_i32 v188, v188
    v_cvt_f32_i32 v189, v189
    v_pk_fma_f32 v[184:185], v[184:185], v[124:125], v[124:125] op_sel:[0,0,1] op_sel_hi:[1,0,1]
    v_pk_fma_f32 v[188:189], v[188:189], v[126:127], v[126:127] op_sel:[0,0,1] op_sel_hi:[1,0,1]
    v_cvt_pk_bf16_f32 v51, v184, v188
    ds_write_b128 v6, v[48:51] offset:18560
    v_cvt_f32_i32 v186, v186
    v_cvt_f32_i32 v187, v187
    v_cvt_f32_i32 v190, v190
    v_cvt_f32_i32 v191, v191
    v_cvt_pk_bf16_f32 v55, v185, v189
    ds_write_b128 v6, v[52:55] offset:19136
    v_pk_fma_f32 v[186:187], v[186:187], v[124:125], v[124:125] op_sel:[0,0,1] op_sel_hi:[1,0,1]
    v_pk_fma_f32 v[190:191], v[190:191], v[126:127], v[126:127] op_sel:[0,0,1] op_sel_hi:[1,0,1]
    v_cvt_pk_bf16_f32 v59, v186, v190
    ds_write_b128 v6, v[56:59] offset:19712
    v_cvt_pk_bf16_f32 v63, v187, v191
    ds_write_b128 v6, v[60:63] offset:20288
    s_waitcnt lgkmcnt(0)
    s_barrier
    s_cbranch_scc1 L_pvc
    ds_read_b128 v[208:211], v7 offset:18560
    ds_read_b128 v[212:215], v7 offset:18576
    ds_read_b128 v[216:219], v7 offset:27840
    ds_read_b128 v[220:223], v7 offset:27856
    ds_read_b128 v[224:227], v7 offset:18688
    ds_read_b128 v[228:231], v7 offset:18704
    ds_read_b128 v[232:235], v7 offset:27968
    ds_read_b128 v[236:239], v7 offset:27984
    s_waitcnt lgkmcnt(6)
    v_mfma_f32_16x16x32_bf16 v[64:67], v[208:211], v[200:203], v[64:67]
    ds_read_b128 v[240:243], v7 offset:18816
    v_mfma_f32_16x16x32_bf16 v[68:71], v[212:215], v[200:203], v[68:71]
    ds_read_b128 v[244:247], v7 offset:18832
    s_waitcnt lgkmcnt(6)
    v_mfma_f32_16x16x32_bf16 v[64:67], v[216:219], v[204:207], v[64:67]
    ds_read_b128 v[208:211], v7 offset:28096
    v_mfma_f32_16x16x32_bf16 v[68:71], v[220:223], v[204:207], v[68:71]
    ds_read_b128 v[212:215], v7 offset:28112
    s_waitcnt lgkmcnt(6)
    v_mfma_f32_16x16x32_bf16 v[72:75], v[224:227], v[200:203], v[72:75]
    ds_read_b128 v[216:219], v7 offset:18944
    v_mfma_f32_16x16x32_bf16 v[76:79], v[228:231], v[200:203], v[76:79]
    ds_read_b128 v[220:223], v7 offset:18960
    s_waitcnt lgkmcnt(6)
    v_mfma_f32_16x16x32_bf16 v[72:75], v[232:235], v[204:207], v[72:75]
    ds_read_b128 v[224:227], v7 offset:28224
    v_cvt_pk_bf16_f32 v96, v64, v65
    v_cvt_pk_bf16_f32 v97, v66, v67
    v_mfma_f32_16x16x32_bf16 v[76:79], v[236:239], v[204:207], v[76:79]
    ds_read_b128 v[228:231], v7 offset:28240
    v_cvt_pk_bf16_f32 v98, v68, v69
    v_cvt_pk_bf16_f32 v99, v70, v71
    buffer_store_dwordx4 v[96:99], v11, s[28:31], s75 offen offset:0 sc0 sc1
    s_waitcnt lgkmcnt(6)
    v_mfma_f32_16x16x32_bf16 v[80:83], v[240:243], v[200:203], v[80:83]
    v_mfma_f32_16x16x32_bf16 v[84:87], v[244:247], v[200:203], v[84:87]
    s_waitcnt lgkmcnt(4)
    v_mfma_f32_16x16x32_bf16 v[80:83], v[208:211], v[204:207], v[80:83]
    v_mfma_f32_16x16x32_bf16 v[84:87], v[212:215], v[204:207], v[84:87]
    s_waitcnt lgkmcnt(2)
    v_mfma_f32_16x16x32_bf16 v[88:91], v[216:219], v[200:203], v[88:91]
    v_cvt_pk_bf16_f32 v100, v72, v73
    v_cvt_pk_bf16_f32 v101, v74, v75
    v_mfma_f32_16x16x32_bf16 v[92:95], v[220:223], v[200:203], v[92:95]
    v_cvt_pk_bf16_f32 v102, v76, v77
    v_cvt_pk_bf16_f32 v103, v78, v79
    buffer_store_dwordx4 v[100:103], v11, s[28:31], s75 offen offset:1024 sc0 sc1
    s_waitcnt lgkmcnt(0)
    v_mfma_f32_16x16x32_bf16 v[88:91], v[224:227], v[204:207], v[88:91]
    v_mfma_f32_16x16x32_bf16 v[92:95], v[228:231], v[204:207], v[92:95]
    v_cvt_pk_bf16_f32 v104, v80, v81
    v_cvt_pk_bf16_f32 v105, v82, v83
    v_cvt_pk_bf16_f32 v106, v84, v85
    v_cvt_pk_bf16_f32 v107, v86, v87
    buffer_store_dwordx4 v[104:107], v11, s[28:31], s75 offen offset:2048 sc0 sc1
    s_nop 1
    v_cvt_pk_bf16_f32 v108, v88, v89
    v_cvt_pk_bf16_f32 v109, v90, v91
    v_cvt_pk_bf16_f32 v110, v92, v93
    v_cvt_pk_bf16_f32 v111, v94, v95
    buffer_store_dwordx4 v[108:111], v11, s[28:31], s75 offen offset:3072 sc0 sc1
    s_mov_b64 exec, 0xffff
    v_min_u32 v12, -2, v248
    v_min_u32_e64 v13, -2, v13
    s_waitcnt vmcnt(0)
    buffer_store_dwordx2 v[12:13], v20, s[28:31], s44 offen sc0 sc1
    s_endpgm
L_pvc:
    ds_read_b128 v[208:211], v7 offset:18560
    ds_read_b128 v[212:215], v7 offset:18576
    ds_read_b128 v[216:219], v7 offset:18688
    ds_read_b128 v[220:223], v7 offset:18704
    ds_read_b128 v[224:227], v7 offset:18816
    ds_read_b128 v[228:231], v7 offset:18832
    ds_read_b128 v[232:235], v7 offset:18944
    ds_read_b128 v[236:239], v7 offset:18960
    s_waitcnt lgkmcnt(6)
    v_mfma_f32_16x16x32_bf16 v[64:67], v[208:211], v[200:203], v[64:67]
    ds_read_b128 v[240:243], v7 offset:27840
    v_mfma_f32_16x16x32_bf16 v[68:71], v[212:215], v[200:203], v[68:71]
    ds_read_b128 v[244:247], v7 offset:27856
    s_waitcnt lgkmcnt(6)
    v_mfma_f32_16x16x32_bf16 v[72:75], v[216:219], v[200:203], v[72:75]
    ds_read_b128 v[208:211], v7 offset:27968
    v_mfma_f32_16x16x32_bf16 v[76:79], v[220:223], v[200:203], v[76:79]
    ds_read_b128 v[212:215], v7 offset:27984
    s_waitcnt lgkmcnt(6)
    v_mfma_f32_16x16x32_bf16 v[80:83], v[224:227], v[200:203], v[80:83]
    ds_read_b128 v[216:219], v7 offset:28096
    v_mfma_f32_16x16x32_bf16 v[84:87], v[228:231], v[200:203], v[84:87]
    ds_read_b128 v[220:223], v7 offset:28112
    s_waitcnt lgkmcnt(6)
    v_mfma_f32_16x16x32_bf16 v[88:91], v[232:235], v[200:203], v[88:91]
    ds_read_b128 v[224:227], v7 offset:28224
    v_mfma_f32_16x16x32_bf16 v[92:95], v[236:239], v[200:203], v[92:95]
    ds_read_b128 v[228:231], v7 offset:28240
    s_waitcnt lgkmcnt(6)
    v_mfma_f32_16x16x32_bf16 v[64:67], v[240:243], v[204:207], v[64:67]
    v_mfma_f32_16x16x32_bf16 v[68:71], v[244:247], v[204:207], v[68:71]
    s_waitcnt lgkmcnt(4)
    v_mfma_f32_16x16x32_bf16 v[72:75], v[208:211], v[204:207], v[72:75]
    v_mfma_f32_16x16x32_bf16 v[76:79], v[212:215], v[204:207], v[76:79]
    s_waitcnt lgkmcnt(2)
    v_mfma_f32_16x16x32_bf16 v[80:83], v[216:219], v[204:207], v[80:83]
    v_mfma_f32_16x16x32_bf16 v[84:87], v[220:223], v[204:207], v[84:87]
    s_waitcnt lgkmcnt(0)
    v_mfma_f32_16x16x32_bf16 v[88:91], v[224:227], v[204:207], v[88:91]
    v_mfma_f32_16x16x32_bf16 v[92:95], v[228:231], v[204:207], v[92:95]
    s_branch L_merge
L_look:
    buffer_load_dwordx2 v[24:25], v20, s[28:31], s44 offen sc0 sc1
    s_sub_u32 s56, s56, 1
    s_cbranch_scc1 L_end
L_merge:
    s_waitcnt vmcnt(0)
    v_max_u32_e64 v35, v24, v25
    v_cmp_eq_u32 vcc, -1, v35
    s_lshr_b32 s45, vcc_lo, 16
    s_cselect_b32 s59, 0, 2
    s_and_b32 s45, vcc_hi, 0xffff
    s_cselect_b32 s45, 0, 4
    s_or_b32 s59, s59, s45
    s_lshr_b32 s45, vcc_hi, 16
    s_cselect_b32 s45, 0, 8
    s_or_b32 s59, s59, s45
    s_and_b32 s59, s59, s55
    s_cbranch_scc0 L_look
    s_bitcmp1_b32 s59, 1
    s_cbranch_scc0 L_get1
    buffer_load_dwordx4 v[128:131], v11, s[28:31], s76 offen offset:0 sc0 sc1
    buffer_load_dwordx4 v[132:135], v11, s[28:31], s76 offen offset:1024 sc0 sc1
    buffer_load_dwordx4 v[136:139], v11, s[28:31], s76 offen offset:2048 sc0 sc1
    buffer_load_dwordx4 v[140:143], v11, s[28:31], s76 offen offset:3072 sc0 sc1
L_get1:
    s_bitcmp1_b32 s59, 2
    s_cbranch_scc0 L_get2
    buffer_load_dwordx4 v[144:147], v11, s[28:31], s77 offen offset:0 sc0 sc1
    buffer_load_dwordx4 v[148:151], v11, s[28:31], s77 offen offset:1024 sc0 sc1
    buffer_load_dwordx4 v[152:155], v11, s[28:31], s77 offen offset:2048 sc0 sc1
    buffer_load_dwordx4 v[156:159], v11, s[28:31], s77 offen offset:3072 sc0 sc1
L_get2:
    s_bitcmp1_b32 s59, 3
    s_cbranch_scc0 L_get3
    buffer_load_dwordx4 v[160:163], v11, s[28:31], s78 offen offset:0 sc0 sc1
    buffer_load_dwordx4 v[164:167], v11, s[28:31], s78 offen offset:1024 sc0 sc1
    buffer_load_dwordx4 v[168:171], v11, s[28:31], s78 offen offset:2048 sc0 sc1
    buffer_load_dwordx4 v[172:175], v11, s[28:31], s78 offen offset:3072 sc0 sc1
L_get3:
    s_andn2_b32 s55, s55, s59
    s_cbranch_scc1 L_look
    ds_bpermute_b32 v40, v21, v24 offset:64
    ds_bpermute_b32 v41, v21, v25 offset:64
    ds_bpermute_b32 v42, v21, v24 offset:128
    ds_bpermute_b32 v43, v21, v25 offset:128
    ds_bpermute_b32 v44, v21, v24 offset:192
    ds_bpermute_b32 v45, v21, v25 offset:192
    v_and_b32 v34, 15, v0
    v_lshrrev_b32 v35, 4, v0
    v_lshlrev_b32 v34, 8, v34
    v_lshl_add_u32 v34, v35, 4, v34
    s_xor_b32 s83, s59, 14
    s_lshl_b32 s46, s3, 12
    s_waitcnt lgkmcnt(0)
    v_min3_f32 v37, v248, v40, v42
    v_min_f32 v37, v37, v44
    v_sub_f32 v28, v37, v248
    v_sub_f32 v30, v37, v40
    v_sub_f32 v24, v37, v42
    v_sub_f32 v26, v37, v44
    v_exp_f32 v28, v28
    v_exp_f32 v30, v30
    v_exp_f32 v24, v24
    v_exp_f32 v26, v26
    v_mul_f32 v13, v13, v28
    v_fmac_f32 v13, v41, v30
    v_fmac_f32 v13, v43, v24
    v_fmac_f32 v13, v45, v26
    v_rcp_f32 v13, v13
    s_nop 0
    v_mul_f32 v28, v28, v13
    v_mul_f32 v30, v30, v13
    v_mul_f32 v24, v24, v13
    v_mul_f32 v26, v26, v13
    v_pk_mul_f32 v[64:65], v[64:65], v[28:29] op_sel_hi:[1,0]
    v_pk_mul_f32 v[66:67], v[66:67], v[28:29] op_sel_hi:[1,0]
    v_pk_mul_f32 v[68:69], v[68:69], v[28:29] op_sel_hi:[1,0]
    v_pk_mul_f32 v[70:71], v[70:71], v[28:29] op_sel_hi:[1,0]
    v_pk_mul_f32 v[72:73], v[72:73], v[28:29] op_sel_hi:[1,0]
    v_pk_mul_f32 v[74:75], v[74:75], v[28:29] op_sel_hi:[1,0]
    v_pk_mul_f32 v[76:77], v[76:77], v[28:29] op_sel_hi:[1,0]
    v_pk_mul_f32 v[78:79], v[78:79], v[28:29] op_sel_hi:[1,0]
    v_pk_mul_f32 v[80:81], v[80:81], v[28:29] op_sel_hi:[1,0]
    v_pk_mul_f32 v[82:83], v[82:83], v[28:29] op_sel_hi:[1,0]
    v_pk_mul_f32 v[84:85], v[84:85], v[28:29] op_sel_hi:[1,0]
    v_pk_mul_f32 v[86:87], v[86:87], v[28:29] op_sel_hi:[1,0]
    v_pk_mul_f32 v[88:89], v[88:89], v[28:29] op_sel_hi:[1,0]
    v_pk_mul_f32 v[90:91], v[90:91], v[28:29] op_sel_hi:[1,0]
    v_pk_mul_f32 v[92:93], v[92:93], v[28:29] op_sel_hi:[1,0]
    v_pk_mul_f32 v[94:95], v[94:95], v[28:29] op_sel_hi:[1,0]
L_pass:
    s_bitcmp1_b32 s83, 1
    s_cbranch_scc0 L_fold1
    s_waitcnt vmcnt(8)
L_in1:
    v_lshlrev_b32 v48, 16, v128
    v_lshlrev_b32 v50, 16, v129
    v_lshlrev_b32 v52, 16, v130
    v_lshlrev_b32 v54, 16, v131
    v_lshlrev_b32 v56, 16, v132
    v_lshlrev_b32 v58, 16, v133
    v_lshlrev_b32 v60, 16, v134
    v_lshlrev_b32_e64 v62, 16, v135
    v_and_b32 v49, 0xffff0000, v128
    v_and_b32 v51, 0xffff0000, v129
    v_and_b32 v53, 0xffff0000, v130
    v_and_b32 v55, 0xffff0000, v131
    v_and_b32 v57, 0xffff0000, v132
    v_and_b32 v59, 0xffff0000, v133
    v_and_b32 v61, 0xffff0000, v134
    v_and_b32 v63, 0xffff0000, v135
    v_pk_fma_f32 v[64:65], v[48:49], v[30:31], v[64:65] op_sel_hi:[1,0,1]
    v_pk_fma_f32 v[66:67], v[50:51], v[30:31], v[66:67] op_sel_hi:[1,0,1]
    v_pk_fma_f32 v[68:69], v[52:53], v[30:31], v[68:69] op_sel_hi:[1,0,1]
    v_pk_fma_f32 v[70:71], v[54:55], v[30:31], v[70:71] op_sel_hi:[1,0,1]
    v_pk_fma_f32 v[72:73], v[56:57], v[30:31], v[72:73] op_sel_hi:[1,0,1]
    v_pk_fma_f32 v[74:75], v[58:59], v[30:31], v[74:75] op_sel_hi:[1,0,1]
    v_pk_fma_f32 v[76:77], v[60:61], v[30:31], v[76:77] op_sel_hi:[1,0,1]
    v_pk_fma_f32 v[78:79], v[62:63], v[30:31], v[78:79] op_sel_hi:[1,0,1]
    v_lshlrev_b32 v48, 16, v136
    v_lshlrev_b32 v50, 16, v137
    v_lshlrev_b32 v52, 16, v138
    v_lshlrev_b32 v54, 16, v139
    v_lshlrev_b32 v56, 16, v140
    v_lshlrev_b32 v58, 16, v141
    v_lshlrev_b32 v60, 16, v142
    v_lshlrev_b32 v62, 16, v143
    v_and_b32 v49, 0xffff0000, v136
    v_and_b32 v51, 0xffff0000, v137
    v_and_b32 v53, 0xffff0000, v138
    v_and_b32 v55, 0xffff0000, v139
    v_and_b32 v57, 0xffff0000, v140
    v_and_b32 v59, 0xffff0000, v141
    v_and_b32 v61, 0xffff0000, v142
    v_and_b32 v63, 0xffff0000, v143
    v_pk_fma_f32 v[80:81], v[48:49], v[30:31], v[80:81] op_sel_hi:[1,0,1]
    v_pk_fma_f32 v[82:83], v[50:51], v[30:31], v[82:83] op_sel_hi:[1,0,1]
    v_pk_fma_f32 v[84:85], v[52:53], v[30:31], v[84:85] op_sel_hi:[1,0,1]
    v_pk_fma_f32 v[86:87], v[54:55], v[30:31], v[86:87] op_sel_hi:[1,0,1]
    v_pk_fma_f32 v[88:89], v[56:57], v[30:31], v[88:89] op_sel_hi:[1,0,1]
    v_pk_fma_f32 v[90:91], v[58:59], v[30:31], v[90:91] op_sel_hi:[1,0,1]
    v_pk_fma_f32 v[92:93], v[60:61], v[30:31], v[92:93] op_sel_hi:[1,0,1]
    v_pk_fma_f32 v[94:95], v[62:63], v[30:31], v[94:95] op_sel_hi:[1,0,1]
L_fold1:
    s_bitcmp1_b32 s83, 2
    s_cbranch_scc0 L_fold2
    s_cmp_lg_u32 s59, 0
    s_cbranch_scc1 L_in2
    s_waitcnt vmcnt(4)
L_in2:
    v_lshlrev_b32 v48, 16, v144
    v_lshlrev_b32 v50, 16, v145
    v_lshlrev_b32 v52, 16, v146
    v_lshlrev_b32 v54, 16, v147
    v_lshlrev_b32 v56, 16, v148
    v_lshlrev_b32 v58, 16, v149
    v_lshlrev_b32 v60, 16, v150
    v_lshlrev_b32_e64 v62, 16, v151
    v_and_b32 v49, 0xffff0000, v144
    v_and_b32 v51, 0xffff0000, v145
    v_and_b32 v53, 0xffff0000, v146
    v_and_b32 v55, 0xffff0000, v147
    v_and_b32 v57, 0xffff0000, v148
    v_and_b32 v59, 0xffff0000, v149
    v_and_b32 v61, 0xffff0000, v150
    v_and_b32 v63, 0xffff0000, v151
    v_pk_fma_f32 v[64:65], v[48:49], v[24:25], v[64:65] op_sel_hi:[1,0,1]
    v_pk_fma_f32 v[66:67], v[50:51], v[24:25], v[66:67] op_sel_hi:[1,0,1]
    v_pk_fma_f32 v[68:69], v[52:53], v[24:25], v[68:69] op_sel_hi:[1,0,1]
    v_pk_fma_f32 v[70:71], v[54:55], v[24:25], v[70:71] op_sel_hi:[1,0,1]
    v_pk_fma_f32 v[72:73], v[56:57], v[24:25], v[72:73] op_sel_hi:[1,0,1]
    v_pk_fma_f32 v[74:75], v[58:59], v[24:25], v[74:75] op_sel_hi:[1,0,1]
    v_pk_fma_f32 v[76:77], v[60:61], v[24:25], v[76:77] op_sel_hi:[1,0,1]
    v_pk_fma_f32 v[78:79], v[62:63], v[24:25], v[78:79] op_sel_hi:[1,0,1]
    v_lshlrev_b32 v48, 16, v152
    v_lshlrev_b32 v50, 16, v153
    v_lshlrev_b32 v52, 16, v154
    v_lshlrev_b32 v54, 16, v155
    v_lshlrev_b32 v56, 16, v156
    v_lshlrev_b32 v58, 16, v157
    v_lshlrev_b32 v60, 16, v158
    v_lshlrev_b32 v62, 16, v159
    v_and_b32 v49, 0xffff0000, v152
    v_and_b32 v51, 0xffff0000, v153
    v_and_b32 v53, 0xffff0000, v154
    v_and_b32 v55, 0xffff0000, v155
    v_and_b32 v57, 0xffff0000, v156
    v_and_b32 v59, 0xffff0000, v157
    v_and_b32 v61, 0xffff0000, v158
    v_and_b32 v63, 0xffff0000, v159
    v_pk_fma_f32 v[80:81], v[48:49], v[24:25], v[80:81] op_sel_hi:[1,0,1]
    v_pk_fma_f32 v[82:83], v[50:51], v[24:25], v[82:83] op_sel_hi:[1,0,1]
    v_pk_fma_f32 v[84:85], v[52:53], v[24:25], v[84:85] op_sel_hi:[1,0,1]
    v_pk_fma_f32 v[86:87], v[54:55], v[24:25], v[86:87] op_sel_hi:[1,0,1]
    v_pk_fma_f32 v[88:89], v[56:57], v[24:25], v[88:89] op_sel_hi:[1,0,1]
    v_pk_fma_f32 v[90:91], v[58:59], v[24:25], v[90:91] op_sel_hi:[1,0,1]
    v_pk_fma_f32 v[92:93], v[60:61], v[24:25], v[92:93] op_sel_hi:[1,0,1]
    v_pk_fma_f32 v[94:95], v[62:63], v[24:25], v[94:95] op_sel_hi:[1,0,1]
L_fold2:
    s_bitcmp1_b32 s83, 3
    s_cbranch_scc0 L_fold3
    s_cmp_lg_u32 s59, 0
    s_cbranch_scc1 L_in3
    s_waitcnt vmcnt(0)
L_in3:
    v_lshlrev_b32 v48, 16, v160
    v_lshlrev_b32 v50, 16, v161
    v_lshlrev_b32 v52, 16, v162
    v_lshlrev_b32 v54, 16, v163
    v_lshlrev_b32 v56, 16, v164
    v_lshlrev_b32 v58, 16, v165
    v_lshlrev_b32 v60, 16, v166
    v_lshlrev_b32_e64 v62, 16, v167
    v_and_b32 v49, 0xffff0000, v160
    v_and_b32 v51, 0xffff0000, v161
    v_and_b32 v53, 0xffff0000, v162
    v_and_b32 v55, 0xffff0000, v163
    v_and_b32 v57, 0xffff0000, v164
    v_and_b32 v59, 0xffff0000, v165
    v_and_b32 v61, 0xffff0000, v166
    v_and_b32 v63, 0xffff0000, v167
    v_pk_fma_f32 v[64:65], v[48:49], v[26:27], v[64:65] op_sel_hi:[1,0,1]
    v_pk_fma_f32 v[66:67], v[50:51], v[26:27], v[66:67] op_sel_hi:[1,0,1]
    v_pk_fma_f32 v[68:69], v[52:53], v[26:27], v[68:69] op_sel_hi:[1,0,1]
    v_pk_fma_f32 v[70:71], v[54:55], v[26:27], v[70:71] op_sel_hi:[1,0,1]
    v_pk_fma_f32 v[72:73], v[56:57], v[26:27], v[72:73] op_sel_hi:[1,0,1]
    v_pk_fma_f32 v[74:75], v[58:59], v[26:27], v[74:75] op_sel_hi:[1,0,1]
    v_pk_fma_f32 v[76:77], v[60:61], v[26:27], v[76:77] op_sel_hi:[1,0,1]
    v_pk_fma_f32 v[78:79], v[62:63], v[26:27], v[78:79] op_sel_hi:[1,0,1]
    v_lshlrev_b32 v48, 16, v168
    v_lshlrev_b32 v50, 16, v169
    v_lshlrev_b32 v52, 16, v170
    v_lshlrev_b32 v54, 16, v171
    v_lshlrev_b32 v56, 16, v172
    v_lshlrev_b32 v58, 16, v173
    v_lshlrev_b32 v60, 16, v174
    v_lshlrev_b32 v62, 16, v175
    v_and_b32 v49, 0xffff0000, v168
    v_and_b32 v51, 0xffff0000, v169
    v_and_b32 v53, 0xffff0000, v170
    v_and_b32 v55, 0xffff0000, v171
    v_and_b32 v57, 0xffff0000, v172
    v_and_b32 v59, 0xffff0000, v173
    v_and_b32 v61, 0xffff0000, v174
    v_and_b32 v63, 0xffff0000, v175
    v_pk_fma_f32 v[80:81], v[48:49], v[26:27], v[80:81] op_sel_hi:[1,0,1]
    v_pk_fma_f32 v[82:83], v[50:51], v[26:27], v[82:83] op_sel_hi:[1,0,1]
    v_pk_fma_f32 v[84:85], v[52:53], v[26:27], v[84:85] op_sel_hi:[1,0,1]
    v_pk_fma_f32 v[86:87], v[54:55], v[26:27], v[86:87] op_sel_hi:[1,0,1]
    v_pk_fma_f32 v[88:89], v[56:57], v[26:27], v[88:89] op_sel_hi:[1,0,1]
    v_pk_fma_f32 v[90:91], v[58:59], v[26:27], v[90:91] op_sel_hi:[1,0,1]
    v_pk_fma_f32 v[92:93], v[60:61], v[26:27], v[92:93] op_sel_hi:[1,0,1]
    v_pk_fma_f32 v[94:95], v[62:63], v[26:27], v[94:95] op_sel_hi:[1,0,1]
L_fold3:
    s_cmp_lg_u32 s59, 0
    s_cbranch_scc1 L_second
L_merged:
    v_cvt_pk_bf16_f32 v96, v64, v65
    v_cvt_pk_bf16_f32 v97, v66, v67
    v_cvt_pk_bf16_f32 v98, v68, v69
    v_cvt_pk_bf16_f32 v99, v70, v71
    buffer_store_dwordx4 v[96:99], v34, s[32:35], s46 offen offset:0 sc0 sc1
    v_cvt_pk_bf16_f32 v100, v72, v73
    v_cvt_pk_bf16_f32 v101, v74, v75
    v_cvt_pk_bf16_f32 v102, v76, v77
    v_cvt_pk_bf16_f32 v103, v78, v79
    buffer_store_dwordx4 v[100:103], v34, s[32:35], s46 offen offset:64 sc0 sc1
    v_cvt_pk_bf16_f32 v104, v80, v81
    v_cvt_pk_bf16_f32 v105, v82, v83
    v_cvt_pk_bf16_f32 v106, v84, v85
    v_cvt_pk_bf16_f32 v107, v86, v87
    buffer_store_dwordx4 v[104:107], v34, s[32:35], s46 offen offset:128 sc0 sc1
    v_cvt_pk_bf16_f32 v108, v88, v89
    v_cvt_pk_bf16_f32 v109, v90, v91
    v_cvt_pk_bf16_f32 v110, v92, v93
    v_cvt_pk_bf16_f32 v111, v94, v95
    buffer_store_dwordx4 v[108:111], v34, s[32:35], s46 offen offset:192 sc0 sc1
L_done:
L_end:
    s_endpgm
L_second:
    s_mov_b32 s83, s59
    s_mov_b32 s59, 0
    s_cmp_eq_u32 s83, 14
    s_cbranch_scc1 L_pass
    s_waitcnt vmcnt(0)
    s_branch L_pass
L_k2v:
    s_mov_b32 s60, s2
    s_add_u32 s61, s60, 4096
    s_xor_b32 s62, s60, 0x4000
    s_xor_b32 s63, s61, 0x4000
    s_mov_b64 s[8:9], s[38:39]
    s_cmp_lg_u32 s57, 0
    s_cbranch_scc0 L_k1
    buffer_load_dword v15, off, s[24:27], 0 offset:4 sc0 sc1
    s_branch L_k1
L_vdisp:
    s_sub_u32 s83, s83, 1
    s_cselect_b32 s59, 0, s59
    s_cbranch_scc1 L_V_
    s_cmp_eq_u32 s59, 1
    s_cbranch_scc1 L_Vf_
    s_branch L_Vs_
L_rdisp:
    s_cmp_eq_u32 s59, 1
    s_cbranch_scc1 L_restf_
    s_branch L_rests_
L_ctl:
    v_readfirstlane_b32 s44, v34
    s_mov_b32 s49, 0
    s_cmp_eq_u32 s43, 16
    s_nop 1
    s_cbranch_scc1 L_last
    s_bitcmp1_b32 0x9040, s43
    s_cbranch_scc0 L_arm
    s_mov_b32 s4, 0x9aabcd
    s_mov_b32 s5, 0x54322110
    s_cmp_eq_u32 s43, 12
    s_cselect_b32 s4, 0x999aab, s4
    s_cselect_b32 s5, 0x32221100, s5
    s_cmp_eq_u32 s43, 15
    s_cselect_b32 s4, 0x999, s4
    s_cselect_b32 s5, 0x11111000, s5
    s_bfe_u32 s45, s44, 0x40001
    s_lshl_b32 s45, s45, 2
    s_lshr_b64 s[4:5], s[4:5], s45
    s_and_b32 s83, s4, 7
    s_bitcmp1_b32 s4, 3
    s_cselect_b32 s59, 2, 1
L_arm:
    s_bitcmp1_b32 0x4820, s43
    s_cselect_b32 s49, s57, 0
    s_lshl3_add_u32 s45, s43, s82
    s_and_b32 s45, s45, 63
    s_lshl_b32 s45, s45, 8
    s_add_u32 s50, s45, 16777216
    s_cmp_eq_u32 s43, 3
    s_cselect_b32 s45, s57, 0
    s_cmp_lg_u32 s45, 0
    s_cbranch_scc0 L_v0
    v_readfirstlane_b32 s45, v15
    s_mov_b64 exec, 1
    s_nop 2
    s_cmp_lg_u32 s45, 0
    s_cbranch_scc1 L_live
    v_mov_b32 v15, 1
    buffer_atomic_add v15, off, s[24:27], 0 sc0
    s_waitcnt vmcnt(0)
    v_readfirstlane_b32 s45, v15
    s_nop 3
    s_cmp_eq_u32 s45, 0
    s_cbranch_scc0 L_flag
    s_mov_b64 exec, -1
    v_lshlrev_b32 v34, 8, v0
    v_mov_b32 v15, 0
    s_mov_b32 s45, 16777216
    buffer_atomic_swap v15, v34, s[28:31], s45 offen sc0
    s_mov_b64 exec, 1
    s_waitcnt vmcnt(0)
    v_mov_b32_e64 v15, 1
    buffer_atomic_or v15, off, s[24:27], 0 offset:4
    s_branch L_live
L_flag:
    v_mov_b32 v15, 0
    buffer_atomic_or v15, off, s[24:27], 0 offset:4 sc0
    s_waitcnt vmcnt(0)
    v_readfirstlane_b32 s45, v15
    s_sub_u32 s56, s56, 1
    s_cbranch_scc1 L_live
    s_nop 2
    s_cmp_lg_u32 s45, 0
    s_cbranch_scc0 L_flag
L_live:
    s_mov_b64 exec, -1
    s_branch L_v0
L_restore:
    s_cmp_ge_u32 s43, 8
    s_cbranch_scc1 L_r8_15
    s_cmp_ge_u32 s43, 4
    s_cbranch_scc1 L_r4_7
    s_cmp_ge_u32 s43, 2
    s_cbranch_scc1 L_r2_3
    v_accvgpr_read_b32 v37, a16
    v_accvgpr_read_b32 v96, a0
    v_accvgpr_read_b32 v97, a1
    v_accvgpr_read_b32 v98, a2
    v_accvgpr_read_b32 v99, a3
    v_accvgpr_read_b32 v100, a4
    v_accvgpr_read_b32 v101, a5
    v_accvgpr_read_b32 v102, a6
    v_accvgpr_read_b32 v103, a7
    v_accvgpr_read_b32 v104, a8
    v_accvgpr_read_b32 v105, a9
    v_accvgpr_read_b32 v106, a10
    v_accvgpr_read_b32 v107, a11
    v_accvgpr_read_b32 v108, a12
    v_accvgpr_read_b32 v109, a13
    v_accvgpr_read_b32 v110, a14
    v_accvgpr_read_b32 v111, a15
    v_cmp_neq_f32 vcc, v37, v39
    s_cbranch_vccz L_restored
    s_branch L_oldref
L_r2_3:
    s_cmp_ge_u32 s43, 3
    s_cbranch_scc1 L_r3_3
    v_accvgpr_read_b32 v37, a33
    v_accvgpr_read_b32 v96, a17
    v_accvgpr_read_b32 v97, a18
    v_accvgpr_read_b32 v98, a19
    v_accvgpr_read_b32 v99, a20
    v_accvgpr_read_b32 v100, a21
    v_accvgpr_read_b32 v101, a22
    v_accvgpr_read_b32 v102, a23
    v_accvgpr_read_b32 v103, a24
    v_accvgpr_read_b32 v104, a25
    v_accvgpr_read_b32 v105, a26
    v_accvgpr_read_b32 v106, a27
    v_accvgpr_read_b32 v107, a28
    v_accvgpr_read_b32 v108, a29
    v_accvgpr_read_b32 v109, a30
    v_accvgpr_read_b32 v110, a31
    v_accvgpr_read_b32 v111, a32
    v_cmp_neq_f32 vcc, v37, v39
    s_cbranch_vccz L_restored
    s_branch L_oldref
L_r3_3:
    v_accvgpr_read_b32 v37, a50
    v_accvgpr_read_b32 v96, a34
    v_accvgpr_read_b32 v97, a35
    v_accvgpr_read_b32 v98, a36
    v_accvgpr_read_b32 v99, a37
    v_accvgpr_read_b32 v100, a38
    v_accvgpr_read_b32 v101, a39
    v_accvgpr_read_b32 v102, a40
    v_accvgpr_read_b32 v103, a41
    v_accvgpr_read_b32 v104, a42
    v_accvgpr_read_b32 v105, a43
    v_accvgpr_read_b32 v106, a44
    v_accvgpr_read_b32 v107, a45
    v_accvgpr_read_b32 v108, a46
    v_accvgpr_read_b32 v109, a47
    v_accvgpr_read_b32 v110, a48
    v_accvgpr_read_b32 v111, a49
    v_cmp_neq_f32 vcc, v37, v39
    s_cbranch_vccz L_restored
    s_branch L_oldref
L_r4_7:
    s_cmp_ge_u32 s43, 6
    s_cbranch_scc1 L_r6_7
    s_cmp_ge_u32 s43, 5
    s_cbranch_scc1 L_r5_5
    v_accvgpr_read_b32 v37, a67
    v_accvgpr_read_b32 v96, a51
    v_accvgpr_read_b32 v97, a52
    v_accvgpr_read_b32 v98, a53
    v_accvgpr_read_b32 v99, a54
    v_accvgpr_read_b32 v100, a55
    v_accvgpr_read_b32 v101, a56
    v_accvgpr_read_b32 v102, a57
    v_accvgpr_read_b32 v103, a58
    v_accvgpr_read_b32 v104, a59
    v_accvgpr_read_b32 v105, a60
    v_accvgpr_read_b32 v106, a61
    v_accvgpr_read_b32 v107, a62
    v_accvgpr_read_b32 v108, a63
    v_accvgpr_read_b32 v109, a64
    v_accvgpr_read_b32 v110, a65
    v_accvgpr_read_b32 v111, a66
    v_cmp_neq_f32 vcc, v37, v39
    s_cbranch_vccz L_restored
    s_branch L_oldref
L_r5_5:
    v_accvgpr_read_b32 v37, a84
    v_accvgpr_read_b32 v96, a68
    v_accvgpr_read_b32 v97, a69
    v_accvgpr_read_b32 v98, a70
    v_accvgpr_read_b32 v99, a71
    v_accvgpr_read_b32 v100, a72
    v_accvgpr_read_b32 v101, a73
    v_accvgpr_read_b32 v102, a74
    v_accvgpr_read_b32 v103, a75
    v_accvgpr_read_b32 v104, a76
    v_accvgpr_read_b32 v105, a77
    v_accvgpr_read_b32 v106, a78
    v_accvgpr_read_b32 v107, a79
    v_accvgpr_read_b32 v108, a80
    v_accvgpr_read_b32 v109, a81
    v_accvgpr_read_b32 v110, a82
    v_accvgpr_read_b32 v111, a83
    v_cmp_neq_f32 vcc, v37, v39
    s_cbranch_vccz L_restored
    s_branch L_oldref
L_r6_7:
    s_cmp_ge_u32 s43, 7
    s_cbranch_scc1 L_r7_7
    v_accvgpr_read_b32 v37, a101
    v_accvgpr_read_b32 v96, a85
    v_accvgpr_read_b32 v97, a86
    v_accvgpr_read_b32 v98, a87
    v_accvgpr_read_b32 v99, a88
    v_accvgpr_read_b32 v100, a89
    v_accvgpr_read_b32 v101, a90
    v_accvgpr_read_b32 v102, a91
    v_accvgpr_read_b32 v103, a92
    v_accvgpr_read_b32 v104, a93
    v_accvgpr_read_b32 v105, a94
    v_accvgpr_read_b32 v106, a95
    v_accvgpr_read_b32 v107, a96
    v_accvgpr_read_b32 v108, a97
    v_accvgpr_read_b32 v109, a98
    v_accvgpr_read_b32 v110, a99
    v_accvgpr_read_b32 v111, a100
    v_cmp_neq_f32 vcc, v37, v39
    s_cbranch_vccz L_restored
    s_branch L_oldref
L_r7_7:
    v_accvgpr_read_b32 v37, a118
    v_accvgpr_read_b32 v96, a102
    v_accvgpr_read_b32 v97, a103
    v_accvgpr_read_b32 v98, a104
    v_accvgpr_read_b32 v99, a105
    v_accvgpr_read_b32 v100, a106
    v_accvgpr_read_b32 v101, a107
    v_accvgpr_read_b32 v102, a108
    v_accvgpr_read_b32 v103, a109
    v_accvgpr_read_b32 v104, a110
    v_accvgpr_read_b32 v105, a111
    v_accvgpr_read_b32 v106, a112
    v_accvgpr_read_b32 v107, a113
    v_accvgpr_read_b32 v108, a114
    v_accvgpr_read_b32 v109, a115
    v_accvgpr_read_b32 v110, a116
    v_accvgpr_read_b32 v111, a117
    v_cmp_neq_f32 vcc, v37, v39
    s_cbranch_vccz L_restored
    s_branch L_oldref
L_r8_15:
    s_cmp_ge_u32 s43, 12
    s_cbranch_scc1 L_r12_15
    s_cmp_ge_u32 s43, 10
    s_cbranch_scc1 L_r10_11
    s_cmp_ge_u32 s43, 9
    s_cbranch_scc1 L_r9_9
    v_accvgpr_read_b32 v37, a135
    v_accvgpr_read_b32 v96, a119
    v_accvgpr_read_b32 v97, a120
    v_accvgpr_read_b32 v98, a121
    v_accvgpr_read_b32 v99, a122
    v_accvgpr_read_b32 v100, a123
    v_accvgpr_read_b32 v101, a124
    v_accvgpr_read_b32 v102, a125
    v_accvgpr_read_b32 v103, a126
    v_accvgpr_read_b32 v104, a127
    v_accvgpr_read_b32 v105, a128
    v_accvgpr_read_b32 v106, a129
    v_accvgpr_read_b32 v107, a130
    v_accvgpr_read_b32 v108, a131
    v_accvgpr_read_b32 v109, a132
    v_accvgpr_read_b32 v110, a133
    v_accvgpr_read_b32 v111, a134
    v_cmp_neq_f32 vcc, v37, v39
    s_cbranch_vccz L_restored
    s_branch L_oldref
L_r9_9:
    v_accvgpr_read_b32 v37, a152
    v_accvgpr_read_b32 v96, a136
    v_accvgpr_read_b32 v97, a137
    v_accvgpr_read_b32 v98, a138
    v_accvgpr_read_b32 v99, a139
    v_accvgpr_read_b32 v100, a140
    v_accvgpr_read_b32 v101, a141
    v_accvgpr_read_b32 v102, a142
    v_accvgpr_read_b32 v103, a143
    v_accvgpr_read_b32 v104, a144
    v_accvgpr_read_b32 v105, a145
    v_accvgpr_read_b32 v106, a146
    v_accvgpr_read_b32 v107, a147
    v_accvgpr_read_b32 v108, a148
    v_accvgpr_read_b32 v109, a149
    v_accvgpr_read_b32 v110, a150
    v_accvgpr_read_b32 v111, a151
    v_cmp_neq_f32 vcc, v37, v39
    s_cbranch_vccz L_restored
    s_branch L_oldref
L_r10_11:
    s_cmp_ge_u32 s43, 11
    s_cbranch_scc1 L_r11_11
    v_accvgpr_read_b32 v37, a169
    v_accvgpr_read_b32 v96, a153
    v_accvgpr_read_b32 v97, a154
    v_accvgpr_read_b32 v98, a155
    v_accvgpr_read_b32 v99, a156
    v_accvgpr_read_b32 v100, a157
    v_accvgpr_read_b32 v101, a158
    v_accvgpr_read_b32 v102, a159
    v_accvgpr_read_b32 v103, a160
    v_accvgpr_read_b32 v104, a161
    v_accvgpr_read_b32 v105, a162
    v_accvgpr_read_b32 v106, a163
    v_accvgpr_read_b32 v107, a164
    v_accvgpr_read_b32 v108, a165
    v_accvgpr_read_b32 v109, a166
    v_accvgpr_read_b32 v110, a167
    v_accvgpr_read_b32 v111, a168
    v_cmp_neq_f32 vcc, v37, v39
    s_cbranch_vccz L_restored
    s_branch L_oldref
L_r11_11:
    v_accvgpr_read_b32 v37, a186
    v_accvgpr_read_b32 v96, a170
    v_accvgpr_read_b32 v97, a171
    v_accvgpr_read_b32 v98, a172
    v_accvgpr_read_b32 v99, a173
    v_accvgpr_read_b32 v100, a174
    v_accvgpr_read_b32 v101, a175
    v_accvgpr_read_b32 v102, a176
    v_accvgpr_read_b32 v103, a177
    v_accvgpr_read_b32 v104, a178
    v_accvgpr_read_b32 v105, a179
    v_accvgpr_read_b32 v106, a180
    v_accvgpr_read_b32 v107, a181
    v_accvgpr_read_b32 v108, a182
    v_accvgpr_read_b32 v109, a183
    v_accvgpr_read_b32 v110, a184
    v_accvgpr_read_b32 v111, a185
    v_cmp_neq_f32 vcc, v37, v39
    s_cbranch_vccz L_restored
    s_branch L_oldref
L_r12_15:
    s_cmp_ge_u32 s43, 14
    s_cbranch_scc1 L_r14_15
    s_cmp_ge_u32 s43, 13
    s_cbranch_scc1 L_r13_13
    v_accvgpr_read_b32 v37, a203
    v_accvgpr_read_b32 v96, a187
    v_accvgpr_read_b32 v97, a188
    v_accvgpr_read_b32 v98, a189
    v_accvgpr_read_b32 v99, a190
    v_accvgpr_read_b32 v100, a191
    v_accvgpr_read_b32 v101, a192
    v_accvgpr_read_b32 v102, a193
    v_accvgpr_read_b32 v103, a194
    v_accvgpr_read_b32 v104, a195
    v_accvgpr_read_b32 v105, a196
    v_accvgpr_read_b32 v106, a197
    v_accvgpr_read_b32 v107, a198
    v_accvgpr_read_b32 v108, a199
    v_accvgpr_read_b32 v109, a200
    v_accvgpr_read_b32 v110, a201
    v_accvgpr_read_b32 v111, a202
    v_cmp_neq_f32 vcc, v37, v39
    s_cbranch_vccz L_restored
    s_branch L_oldref
L_r13_13:
    v_accvgpr_read_b32 v37, a220
    v_accvgpr_read_b32 v96, a204
    v_accvgpr_read_b32 v97, a205
    v_accvgpr_read_b32 v98, a206
    v_accvgpr_read_b32 v99, a207
    v_accvgpr_read_b32 v100, a208
    v_accvgpr_read_b32 v101, a209
    v_accvgpr_read_b32 v102, a210
    v_accvgpr_read_b32 v103, a211
    v_accvgpr_read_b32 v104, a212
    v_accvgpr_read_b32 v105, a213
    v_accvgpr_read_b32 v106, a214
    v_accvgpr_read_b32 v107, a215
    v_accvgpr_read_b32 v108, a216
    v_accvgpr_read_b32 v109, a217
    v_accvgpr_read_b32 v110, a218
    v_accvgpr_read_b32 v111, a219
    v_cmp_neq_f32 vcc, v37, v39
    s_cbranch_vccz L_restored
    s_branch L_oldref
L_r14_15:
    s_cmp_ge_u32 s43, 15
    s_cbranch_scc1 L_r15_15
    v_accvgpr_read_b32 v37, a237
    v_accvgpr_read_b32 v96, a221
    v_accvgpr_read_b32 v97, a222
    v_accvgpr_read_b32 v98, a223
    v_accvgpr_read_b32 v99, a224
    v_accvgpr_read_b32 v100, a225
    v_accvgpr_read_b32 v101, a226
    v_accvgpr_read_b32 v102, a227
    v_accvgpr_read_b32 v103, a228
    v_accvgpr_read_b32 v104, a229
    v_accvgpr_read_b32 v105, a230
    v_accvgpr_read_b32 v106, a231
    v_accvgpr_read_b32 v107, a232
    v_accvgpr_read_b32 v108, a233
    v_accvgpr_read_b32 v109, a234
    v_accvgpr_read_b32 v110, a235
    v_accvgpr_read_b32 v111, a236
    v_cmp_neq_f32 vcc, v37, v39
    s_cbranch_vccz L_restored
    s_branch L_oldref
L_r15_15:
    v_accvgpr_read_b32 v37, a254
    v_accvgpr_read_b32 v96, a238
    v_accvgpr_read_b32 v97, a239
    v_accvgpr_read_b32 v98, a240
    v_accvgpr_read_b32 v99, a241
    v_accvgpr_read_b32 v100, a242
    v_accvgpr_read_b32 v101, a243
    v_accvgpr_read_b32 v102, a244
    v_accvgpr_read_b32 v103, a245
    v_accvgpr_read_b32 v104, a246
    v_accvgpr_read_b32 v105, a247
    v_accvgpr_read_b32 v106, a248
    v_accvgpr_read_b32 v107, a249
    v_accvgpr_read_b32 v108, a250
    v_accvgpr_read_b32 v109, a251
    v_accvgpr_read_b32 v110, a252
    v_accvgpr_read_b32 v111, a253
    v_cmp_neq_f32 vcc, v37, v39
    s_cbranch_vccz L_restored
    s_branch L_oldref
L_oldref:
    v_sub_f32 v34, v37, v39
    v_exp_f32 v34, v34
    v_mov_b32_e64 v39, v37
    v_pk_mul_f32 v[64:65], v[64:65], v[34:35] op_sel_hi:[1,0]
    v_pk_mul_f32 v[66:67], v[66:67], v[34:35] op_sel_hi:[1,0]
    v_pk_mul_f32 v[68:69], v[68:69], v[34:35] op_sel_hi:[1,0]
    v_pk_mul_f32 v[70:71], v[70:71], v[34:35] op_sel_hi:[1,0]
    v_pk_mul_f32 v[72:73], v[72:73], v[34:35] op_sel_hi:[1,0]
    v_pk_mul_f32 v[74:75], v[74:75], v[34:35] op_sel_hi:[1,0]
    v_pk_mul_f32 v[76:77], v[76:77], v[34:35] op_sel_hi:[1,0]
    v_pk_mul_f32 v[78:79], v[78:79], v[34:35] op_sel_hi:[1,0]
    v_pk_mul_f32 v[80:81], v[80:81], v[34:35] op_sel_hi:[1,0]
    v_pk_mul_f32 v[82:83], v[82:83], v[34:35] op_sel_hi:[1,0]
    v_pk_mul_f32 v[84:85], v[84:85], v[34:35] op_sel_hi:[1,0]
    v_pk_mul_f32 v[86:87], v[86:87], v[34:35] op_sel_hi:[1,0]
    v_pk_mul_f32 v[88:89], v[88:89], v[34:35] op_sel_hi:[1,0]
    v_pk_mul_f32 v[90:91], v[90:91], v[34:35] op_sel_hi:[1,0]
    v_pk_mul_f32 v[92:93], v[92:93], v[34:35] op_sel_hi:[1,0]
    v_pk_mul_f32 v[94:95], v[94:95], v[34:35] op_sel_hi:[1,0]
    s_branch L_restored
L_oldrefE:
    v_sub_f32 v34, v248, v39
    v_exp_f32 v34, v34
    s_nop 0
    v_pk_mul_f32 v[64:65], v[64:65], v[34:35] op_sel_hi:[1,0]
    v_pk_mul_f32 v[66:67], v[66:67], v[34:35] op_sel_hi:[1,0]
    v_pk_mul_f32 v[68:69], v[68:69], v[34:35] op_sel_hi:[1,0]
    v_pk_mul_f32 v[70:71], v[70:71], v[34:35] op_sel_hi:[1,0]
    v_pk_mul_f32 v[72:73], v[72:73], v[34:35] op_sel_hi:[1,0]
    v_pk_mul_f32 v[74:75], v[74:75], v[34:35] op_sel_hi:[1,0]
    v_pk_mul_f32 v[76:77], v[76:77], v[34:35] op_sel_hi:[1,0]
    v_pk_mul_f32 v[78:79], v[78:79], v[34:35] op_sel_hi:[1,0]
    v_pk_mul_f32 v[80:81], v[80:81], v[34:35] op_sel_hi:[1,0]
    v_pk_mul_f32 v[82:83], v[82:83], v[34:35] op_sel_hi:[1,0]
    v_pk_mul_f32 v[84:85], v[84:85], v[34:35] op_sel_hi:[1,0]
    v_pk_mul_f32 v[86:87], v[86:87], v[34:35] op_sel_hi:[1,0]
    v_pk_mul_f32 v[88:89], v[88:89], v[34:35] op_sel_hi:[1,0]
    v_pk_mul_f32 v[90:91], v[90:91], v[34:35] op_sel_hi:[1,0]
    v_pk_mul_f32 v[92:93], v[92:93], v[34:35] op_sel_hi:[1,0]
    v_pk_mul_f32 v[94:95], v[94:95], v[34:35] op_sel_hi:[1,0]
    s_branch L_newrefE
L_save:
    s_cmp_ge_u32 s42, 9
    s_cbranch_scc1 L_s9_16
    s_cmp_ge_u32 s42, 5
    s_cbranch_scc1 L_s5_8
    s_cmp_ge_u32 s42, 3
    s_cbranch_scc1 L_s3_4
    s_cmp_ge_u32 s42, 2
    s_cbranch_scc1 L_s2_2
    s_branch L_saved
L_s2_2:
    v_accvgpr_write_b32 a0, v96
    v_accvgpr_write_b32 a1, v97
    v_accvgpr_write_b32 a2, v98
    v_accvgpr_write_b32 a3, v99
    v_accvgpr_write_b32 a4, v100
    v_accvgpr_write_b32 a5, v101
    v_accvgpr_write_b32 a6, v102
    v_accvgpr_write_b32 a7, v103
    v_accvgpr_write_b32 a8, v104
    v_accvgpr_write_b32 a9, v105
    v_accvgpr_write_b32 a10, v106
    v_accvgpr_write_b32 a11, v107
    v_accvgpr_write_b32 a12, v108
    v_accvgpr_write_b32 a13, v109
    v_accvgpr_write_b32 a14, v110
    v_accvgpr_write_b32 a15, v111
    v_accvgpr_write_b32 a16, v248
    s_branch L_saved
L_s3_4:
    s_cmp_ge_u32 s42, 4
    s_cbranch_scc1 L_s4_4
    v_accvgpr_write_b32 a17, v96
    v_accvgpr_write_b32 a18, v97
    v_accvgpr_write_b32 a19, v98
    v_accvgpr_write_b32 a20, v99
    v_accvgpr_write_b32 a21, v100
    v_accvgpr_write_b32 a22, v101
    v_accvgpr_write_b32 a23, v102
    v_accvgpr_write_b32 a24, v103
    v_accvgpr_write_b32 a25, v104
    v_accvgpr_write_b32 a26, v105
    v_accvgpr_write_b32 a27, v106
    v_accvgpr_write_b32 a28, v107
    v_accvgpr_write_b32 a29, v108
    v_accvgpr_write_b32 a30, v109
    v_accvgpr_write_b32 a31, v110
    v_accvgpr_write_b32 a32, v111
    v_accvgpr_write_b32 a33, v248
    s_branch L_saved
L_s4_4:
    v_accvgpr_write_b32 a34, v96
    v_accvgpr_write_b32 a35, v97
    v_accvgpr_write_b32 a36, v98
    v_accvgpr_write_b32 a37, v99
    v_accvgpr_write_b32 a38, v100
    v_accvgpr_write_b32 a39, v101
    v_accvgpr_write_b32 a40, v102
    v_accvgpr_write_b32 a41, v103
    v_accvgpr_write_b32 a42, v104
    v_accvgpr_write_b32 a43, v105
    v_accvgpr_write_b32 a44, v106
    v_accvgpr_write_b32 a45, v107
    v_accvgpr_write_b32 a46, v108
    v_accvgpr_write_b32 a47, v109
    v_accvgpr_write_b32 a48, v110
    v_accvgpr_write_b32 a49, v111
    v_accvgpr_write_b32 a50, v248
    s_branch L_saved
L_s5_8:
    s_cmp_ge_u32 s42, 7
    s_cbranch_scc1 L_s7_8
    s_cmp_ge_u32 s42, 6
    s_cbranch_scc1 L_s6_6
    v_accvgpr_write_b32 a51, v96
    v_accvgpr_write_b32 a52, v97
    v_accvgpr_write_b32 a53, v98
    v_accvgpr_write_b32 a54, v99
    v_accvgpr_write_b32 a55, v100
    v_accvgpr_write_b32 a56, v101
    v_accvgpr_write_b32 a57, v102
    v_accvgpr_write_b32 a58, v103
    v_accvgpr_write_b32 a59, v104
    v_accvgpr_write_b32 a60, v105
    v_accvgpr_write_b32 a61, v106
    v_accvgpr_write_b32 a62, v107
    v_accvgpr_write_b32 a63, v108
    v_accvgpr_write_b32 a64, v109
    v_accvgpr_write_b32 a65, v110
    v_accvgpr_write_b32 a66, v111
    v_accvgpr_write_b32 a67, v248
    s_branch L_saved
L_s6_6:
    v_accvgpr_write_b32 a68, v96
    v_accvgpr_write_b32 a69, v97
    v_accvgpr_write_b32 a70, v98
    v_accvgpr_write_b32 a71, v99
    v_accvgpr_write_b32 a72, v100
    v_accvgpr_write_b32 a73, v101
    v_accvgpr_write_b32 a74, v102
    v_accvgpr_write_b32 a75, v103
    v_accvgpr_write_b32 a76, v104
    v_accvgpr_write_b32 a77, v105
    v_accvgpr_write_b32 a78, v106
    v_accvgpr_write_b32 a79, v107
    v_accvgpr_write_b32 a80, v108
    v_accvgpr_write_b32 a81, v109
    v_accvgpr_write_b32 a82, v110
    v_accvgpr_write_b32 a83, v111
    v_accvgpr_write_b32 a84, v248
    s_branch L_saved
L_s7_8:
    s_cmp_ge_u32 s42, 8
    s_cbranch_scc1 L_s8_8
    v_accvgpr_write_b32 a85, v96
    v_accvgpr_write_b32 a86, v97
    v_accvgpr_write_b32 a87, v98
    v_accvgpr_write_b32 a88, v99
    v_accvgpr_write_b32 a89, v100
    v_accvgpr_write_b32 a90, v101
    v_accvgpr_write_b32 a91, v102
    v_accvgpr_write_b32 a92, v103
    v_accvgpr_write_b32 a93, v104
    v_accvgpr_write_b32 a94, v105
    v_accvgpr_write_b32 a95, v106
    v_accvgpr_write_b32 a96, v107
    v_accvgpr_write_b32 a97, v108
    v_accvgpr_write_b32 a98, v109
    v_accvgpr_write_b32 a99, v110
    v_accvgpr_write_b32 a100, v111
    v_accvgpr_write_b32 a101, v248
    s_branch L_saved
L_s8_8:
    v_accvgpr_write_b32 a102, v96
    v_accvgpr_write_b32 a103, v97
    v_accvgpr_write_b32 a104, v98
    v_accvgpr_write_b32 a105, v99
    v_accvgpr_write_b32 a106, v100
    v_accvgpr_write_b32 a107, v101
    v_accvgpr_write_b32 a108, v102
    v_accvgpr_write_b32 a109, v103
    v_accvgpr_write_b32 a110, v104
    v_accvgpr_write_b32 a111, v105
    v_accvgpr_write_b32 a112, v106
    v_accvgpr_write_b32 a113, v107
    v_accvgpr_write_b32 a114, v108
    v_accvgpr_write_b32 a115, v109
    v_accvgpr_write_b32 a116, v110
    v_accvgpr_write_b32 a117, v111
    v_accvgpr_write_b32 a118, v248
    s_branch L_saved
L_s9_16:
    s_cmp_ge_u32 s42, 13
    s_cbranch_scc1 L_s13_16
    s_cmp_ge_u32 s42, 11
    s_cbranch_scc1 L_s11_12
    s_cmp_ge_u32 s42, 10
    s_cbranch_scc1 L_s10_10
    v_accvgpr_write_b32 a119, v96
    v_accvgpr_write_b32 a120, v97
    v_accvgpr_write_b32 a121, v98
    v_accvgpr_write_b32 a122, v99
    v_accvgpr_write_b32 a123, v100
    v_accvgpr_write_b32 a124, v101
    v_accvgpr_write_b32 a125, v102
    v_accvgpr_write_b32 a126, v103
    v_accvgpr_write_b32 a127, v104
    v_accvgpr_write_b32 a128, v105
    v_accvgpr_write_b32 a129, v106
    v_accvgpr_write_b32 a130, v107
    v_accvgpr_write_b32 a131, v108
    v_accvgpr_write_b32 a132, v109
    v_accvgpr_write_b32 a133, v110
    v_accvgpr_write_b32 a134, v111
    v_accvgpr_write_b32 a135, v248
    s_branch L_saved
L_s10_10:
    v_accvgpr_write_b32 a136, v96
    v_accvgpr_write_b32 a137, v97
    v_accvgpr_write_b32 a138, v98
    v_accvgpr_write_b32 a139, v99
    v_accvgpr_write_b32 a140, v100
    v_accvgpr_write_b32 a141, v101
    v_accvgpr_write_b32 a142, v102
    v_accvgpr_write_b32 a143, v103
    v_accvgpr_write_b32 a144, v104
    v_accvgpr_write_b32 a145, v105
    v_accvgpr_write_b32 a146, v106
    v_accvgpr_write_b32 a147, v107
    v_accvgpr_write_b32 a148, v108
    v_accvgpr_write_b32 a149, v109
    v_accvgpr_write_b32 a150, v110
    v_accvgpr_write_b32 a151, v111
    v_accvgpr_write_b32 a152, v248
    s_branch L_saved
L_s11_12:
    s_cmp_ge_u32 s42, 12
    s_cbranch_scc1 L_s12_12
    v_accvgpr_write_b32 a153, v96
    v_accvgpr_write_b32 a154, v97
    v_accvgpr_write_b32 a155, v98
    v_accvgpr_write_b32 a156, v99
    v_accvgpr_write_b32 a157, v100
    v_accvgpr_write_b32 a158, v101
    v_accvgpr_write_b32 a159, v102
    v_accvgpr_write_b32 a160, v103
    v_accvgpr_write_b32 a161, v104
    v_accvgpr_write_b32 a162, v105
    v_accvgpr_write_b32 a163, v106
    v_accvgpr_write_b32 a164, v107
    v_accvgpr_write_b32 a165, v108
    v_accvgpr_write_b32 a166, v109
    v_accvgpr_write_b32 a167, v110
    v_accvgpr_write_b32 a168, v111
    v_accvgpr_write_b32 a169, v248
    s_branch L_saved
L_s12_12:
    v_accvgpr_write_b32 a170, v96
    v_accvgpr_write_b32 a171, v97
    v_accvgpr_write_b32 a172, v98
    v_accvgpr_write_b32 a173, v99
    v_accvgpr_write_b32 a174, v100
    v_accvgpr_write_b32 a175, v101
    v_accvgpr_write_b32 a176, v102
    v_accvgpr_write_b32 a177, v103
    v_accvgpr_write_b32 a178, v104
    v_accvgpr_write_b32 a179, v105
    v_accvgpr_write_b32 a180, v106
    v_accvgpr_write_b32 a181, v107
    v_accvgpr_write_b32 a182, v108
    v_accvgpr_write_b32 a183, v109
    v_accvgpr_write_b32 a184, v110
    v_accvgpr_write_b32 a185, v111
    v_accvgpr_write_b32 a186, v248
    s_branch L_saved
L_s13_16:
    s_cmp_ge_u32 s42, 15
    s_cbranch_scc1 L_s15_16
    s_cmp_ge_u32 s42, 14
    s_cbranch_scc1 L_s14_14
    v_accvgpr_write_b32 a187, v96
    v_accvgpr_write_b32 a188, v97
    v_accvgpr_write_b32 a189, v98
    v_accvgpr_write_b32 a190, v99
    v_accvgpr_write_b32 a191, v100
    v_accvgpr_write_b32 a192, v101
    v_accvgpr_write_b32 a193, v102
    v_accvgpr_write_b32 a194, v103
    v_accvgpr_write_b32 a195, v104
    v_accvgpr_write_b32 a196, v105
    v_accvgpr_write_b32 a197, v106
    v_accvgpr_write_b32 a198, v107
    v_accvgpr_write_b32 a199, v108
    v_accvgpr_write_b32 a200, v109
    v_accvgpr_write_b32 a201, v110
    v_accvgpr_write_b32 a202, v111
    v_accvgpr_write_b32 a203, v248
    s_branch L_saved
L_s14_14:
    v_accvgpr_write_b32 a204, v96
    v_accvgpr_write_b32 a205, v97
    v_accvgpr_write_b32 a206, v98
    v_accvgpr_write_b32 a207, v99
    v_accvgpr_write_b32 a208, v100
    v_accvgpr_write_b32 a209, v101
    v_accvgpr_write_b32 a210, v102
    v_accvgpr_write_b32 a211, v103
    v_accvgpr_write_b32 a212, v104
    v_accvgpr_write_b32 a213, v105
    v_accvgpr_write_b32 a214, v106
    v_accvgpr_write_b32 a215, v107
    v_accvgpr_write_b32 a216, v108
    v_accvgpr_write_b32 a217, v109
    v_accvgpr_write_b32 a218, v110
    v_accvgpr_write_b32 a219, v111
    v_accvgpr_write_b32 a220, v248
    s_branch L_saved
L_s15_16:
    s_cmp_ge_u32 s42, 16
    s_cbranch_scc1 L_s16_16
    v_accvgpr_write_b32 a221, v96
    v_accvgpr_write_b32 a222, v97
    v_accvgpr_write_b32 a223, v98
    v_accvgpr_write_b32 a224, v99
    v_accvgpr_write_b32 a225, v100
    v_accvgpr_write_b32 a226, v101
    v_accvgpr_write_b32 a227, v102
    v_accvgpr_write_b32 a228, v103
    v_accvgpr_write_b32 a229, v104
    v_accvgpr_write_b32 a230, v105
    v_accvgpr_write_b32 a231, v106
    v_accvgpr_write_b32 a232, v107
    v_accvgpr_write_b32 a233, v108
    v_accvgpr_write_b32 a234, v109
    v_accvgpr_write_b32 a235, v110
    v_accvgpr_write_b32 a236, v111
    v_accvgpr_write_b32 a237, v248
    s_branch L_saved
L_s16_16:
    v_accvgpr_write_b32 a238, v96
    v_accvgpr_write_b32 a239, v97
    v_accvgpr_write_b32 a240, v98
    v_accvgpr_write_b32 a241, v99
    v_accvgpr_write_b32 a242, v100
    v_accvgpr_write_b32 a243, v101
    v_accvgpr_write_b32 a244, v102
    v_accvgpr_write_b32 a245, v103
    v_accvgpr_write_b32 a246, v104
    v_accvgpr_write_b32 a247, v105
    v_accvgpr_write_b32 a248, v106
    v_accvgpr_write_b32 a249, v107
    v_accvgpr_write_b32 a250, v108
    v_accvgpr_write_b32 a251, v109
    v_accvgpr_write_b32 a252, v110
    v_accvgpr_write_b32 a253, v111
    v_accvgpr_write_b32 a254, v248
    s_branch L_saved
L_rescaleK:
    v_mov_b32 v34, v37
    s_nop 1
    v_permlane32_swap_b32 v34, v37
    s_nop 1
    v_max_f32 v37, v37, v34
    v_mov_b32 v34, v37
    s_nop 1
    v_permlane16_swap_b32 v34, v37
    s_nop 1
    v_max_f32 v37, v37, v34
    v_max_f32 v34, 0, v37
    v_max_f32_e64 v18, s47, v37
    v_exp_f32 v34, -v34
    s_mov_b32 s48, 0x0
    s_mov_b32 s47, 0
    v_pk_add_f32 v[248:249], v[248:249], v[18:19] op_sel_hi:[1,0] neg_lo:[0,1] neg_hi:[0,1]
    v_pk_add_f32 v[250:251], v[250:251], v[18:19] op_sel_hi:[1,0] neg_lo:[0,1] neg_hi:[0,1]
    v_pk_add_f32 v[96:97], v[96:97], v[18:19] op_sel_hi:[1,0] neg_lo:[0,1] neg_hi:[0,1]
    v_pk_add_f32 v[98:99], v[98:99], v[18:19] op_sel_hi:[1,0] neg_lo:[0,1] neg_hi:[0,1]
    v_pk_add_f32 v[100:101], v[100:101], v[18:19] op_sel_hi:[1,0] neg_lo:[0,1] neg_hi:[0,1]
    v_pk_add_f32 v[102:103], v[102:103], v[18:19] op_sel_hi:[1,0] neg_lo:[0,1] neg_hi:[0,1]
    v_pk_add_f32 v[104:105], v[104:105], v[18:19] op_sel_hi:[1,0] neg_lo:[0,1] neg_hi:[0,1]
    v_pk_add_f32 v[106:107], v[106:107], v[18:19] op_sel_hi:[1,0] neg_lo:[0,1] neg_hi:[0,1]
    v_pk_add_f32 v[108:109], v[108:109], v[18:19] op_sel_hi:[1,0] neg_lo:[0,1] neg_hi:[0,1]
    v_pk_add_f32 v[110:111], v[110:111], v[18:19] op_sel_hi:[1,0] neg_lo:[0,1] neg_hi:[0,1]
    v_pk_add_f32 v[112:113], v[112:113], v[18:19] op_sel_hi:[1,0] neg_lo:[0,1] neg_hi:[0,1]
    v_pk_add_f32 v[114:115], v[114:115], v[18:19] op_sel_hi:[1,0] neg_lo:[0,1] neg_hi:[0,1]
    v_pk_add_f32 v[116:117], v[116:117], v[18:19] op_sel_hi:[1,0] neg_lo:[0,1] neg_hi:[0,1]
    v_pk_add_f32 v[118:119], v[118:119], v[18:19] op_sel_hi:[1,0] neg_lo:[0,1] neg_hi:[0,1]
    v_pk_add_f32 v[120:121], v[120:121], v[18:19] op_sel_hi:[1,0] neg_lo:[0,1] neg_hi:[0,1]
    v_pk_add_f32 v[122:123], v[122:123], v[18:19] op_sel_hi:[1,0] neg_lo:[0,1] neg_hi:[0,1]
    v_pk_add_f32 v[124:125], v[124:125], v[18:19] op_sel_hi:[1,0] neg_lo:[0,1] neg_hi:[0,1]
    v_pk_add_f32 v[126:127], v[126:127], v[18:19] op_sel_hi:[1,0] neg_lo:[0,1] neg_hi:[0,1]
    v_pk_mul_f32 v[16:17], v[16:17], v[34:35] op_sel_hi:[1,0]
    s_branch L_rescaledK
L_hookK:
    s_cmp_eq_u32 s42, 1
    s_cbranch_scc1 L_hk1
    s_cmp_eq_u32 s42, 3
    s_cbranch_scc0 L_k1
    s_mov_b64 exec, 1
    v_mov_b32_e64 v15, 1
    buffer_atomic_or v15, off, s[24:27], 0 offset:4
    s_mov_b64 exec, -1
    s_branch L_k1
L_hk1:
    v_readfirstlane_b32 s45, v15
    s_nop 3
    s_cmp_eq_u32 s45, 0
    s_cselect_b32 s58, 3, 0
    s_cbranch_scc0 L_k1
    v_lshlrev_b32 v34, 8, v0
    v_mov_b32_e64 v15, 0
    s_mov_b32 s45, 16777216
    buffer_atomic_swap v15, v34, s[28:31], s45 offen sc0
    s_branch L_k1
L_codeend:
.section .rodata,"a"
.p2align 6
.amdhsa_kernel standalone__kv_cache_quant_int4_int2_kv_with_per_channel_or_per_token_scales__sampling_kernel
  .amdhsa_next_free_vgpr 512
  .amdhsa_next_free_sgpr 102
  .amdhsa_accum_offset 256
  .amdhsa_group_segment_fixed_size 0
  .amdhsa_kernarg_size 80
  .amdhsa_user_sgpr_count 2
  .amdhsa_user_sgpr_kernarg_segment_ptr 1
  .amdhsa_system_sgpr_workgroup_id_x 1
  .amdhsa_float_denorm_mode_32 3
  .amdhsa_float_denorm_mode_16_64 3
.end_amdhsa_kernel
```
